```python
import torch

def _softmax(x, axis=-1):
    return torch.softmax(x, dim=axis)
def _gelu(x):
    return torch.nn.functional.gelu(x, approximate="tanh")
def _silu(x):
    return torch.nn.functional.silu(x)
def _sigmoid(x):
    return torch.sigmoid(x)
def _layernorm(x, axis=-1, eps=1e-5):
    m = x.mean(dim=axis, keepdim=True)
    v = x.var(dim=axis, keepdim=True, unbiased=False)
    return (x - m) / torch.sqrt(v + eps)
def _scatter_add(tgt, idx, src, axis=0):
    return tgt.clone().index_add_(axis, idx, src)
def _segment_sum(src, seg, n):
    out = torch.zeros((n,) + src.shape[1:], dtype=src.dtype)
    return out.index_add_(0, seg, src)
def _pad(x, pw):
    flat = tuple(v for pair in reversed(pw) for v in pair)
    return torch.nn.functional.pad(x, flat)

kernel_name = 'gated_mix__sliding_block_cached__geglu_ffn__decode'

def setup_inputs():

    _w = (lambda a: (lambda t: t.to(torch.bfloat16) if t.is_floating_point() else t)(torch.as_tensor(a)))
    def _A_setup():
        B, Sq, D = 2, 1, 1024
        Hq, Hkv, Sk, Dh = 32, 4, 32768, 128
        assert Hq % Hkv == 0, (Hq, Hkv)
        return {
            "x": _w((lambda *s: torch.randn(*s, dtype=torch.bfloat16) * 0.05)(B, Sq, D)),
            "k_cache": _w((lambda *s: torch.randn(*s, dtype=torch.bfloat16) * 6.4)(B, Hkv, Sk, Dh)),
            "v_cache": _w((lambda *s: torch.randn(*s, dtype=torch.bfloat16) * 0.4)(B, Hkv, Sk, Dh)),
            "wq": _w((lambda *s: torch.randn(*s, dtype=torch.bfloat16) * 6.4)(D, Hq * Dh) * (D ** -0.5)),
            "wo": _w((lambda *s: torch.randn(*s, dtype=torch.bfloat16) * 0.4)(Hq * Dh, D) * ((Hq * Dh) ** -0.5)),
        }
    _A_in = _A_setup()

    def _B_setup():
        B, S, D, F = 2, 1, 1024, 3584
        return {
            "x": _w((lambda *s: torch.randn(*s, dtype=torch.bfloat16) * 0.05)(B, S, D)),
            "w_gate": _w((lambda *s: torch.randn(*s, dtype=torch.bfloat16) * 0.05)(D, F)),
            "w_up": _w((lambda *s: torch.randn(*s, dtype=torch.bfloat16) * 0.05)(D, F)),
            "w_down": _w((lambda *s: torch.randn(*s, dtype=torch.bfloat16) * 0.05)(F, D)),
        }
    _B_in = _B_setup()

    return {
        "A_x": _A_in["x"],
        "A_k_cache": _A_in["k_cache"],
        "A_v_cache": _A_in["v_cache"],
        "A_wq": _A_in["wq"],
        "A_wo": _A_in["wo"],
        "B_x": _B_in["x"],
        "B_w_gate": _B_in["w_gate"],
        "B_w_up": _B_in["w_up"],
        "B_w_down": _B_in["w_down"],
        "gate_w": _w((lambda *s: torch.randn(*s, dtype=torch.bfloat16) * 0.05)(1024) * 16.0),
    }

def reference(A_x, A_k_cache, A_v_cache, A_wq, A_wo, B_x, B_w_gate, B_w_up, B_w_down, gate_w):
    def _A_ref(x, k_cache, v_cache, wq, wo):
        B, Sq, D = x.shape
        Hq, Dh = 32, 128
        Hkv, Sk = k_cache.shape[1], k_cache.shape[2]
        W = min(4096, max(256, Sk // 4))
        rep = Hq // Hkv
        q = (lambda x, *d: x.permute(*d))((x @ wq).reshape(B, Sq, Hq, Dh), 0, 2, 1, 3)
        k = (lambda x, n, axis: torch.repeat_interleave(x, n, dim=axis))(k_cache[:, :, Sk - W:, :], rep, axis=1)
        v = (lambda x, n, axis: torch.repeat_interleave(x, n, dim=axis))(v_cache[:, :, Sk - W:, :], rep, axis=1)
        scores = torch.einsum("bhqd,bhkd->bhqk", q, k) * (Dh ** -0.5)
        p = _softmax(scores, axis=-1)
        o = torch.einsum("bhqk,bhkd->bhqd", p, v)
        return (lambda x, *d: x.permute(*d))(o, 0, 2, 1, 3).reshape(B, Sq, Hq * Dh) @ wo

    def _B_ref(x, w_gate, w_up, w_down):
        return (_gelu(x @ w_gate) * (x @ w_up)) @ w_down

    x = A_x
    g = _sigmoid((x * gate_w).sum(-1, keepdims=True))
    a = _A_ref(x, A_k_cache, A_v_cache, A_wq, A_wo)
    b = _B_ref(x, B_w_gate, B_w_up, B_w_down)
    return g * a + (1 - g) * b
```

```asm
; @launch grid=(256,1,1) block=(512,1,1) lds=146752
.amdgcn_target "amdgcn-amd-amdhsa--gfx950"
.text
.globl gated_mix__sliding_block_cached__geglu_ffn__decode_kernel
.p2align 8
.type gated_mix__sliding_block_cached__geglu_ffn__decode_kernel,@function
gated_mix__sliding_block_cached__geglu_ffn__decode_kernel:
    s_cmp_ge_u32 s2, 256
    s_cbranch_scc1 L_end
    s_load_dwordx16 s[4:19], s[0:1], 0
    s_load_dwordx8 s[20:27], s[0:1], 64
    s_load_dwordx2 s[96:97], s[0:1], 96
    s_getpc_b64 s[42:43]
L_pc:
    s_lshr_b32 s37, s2, 2
    s_xor_b32 s37, s37, s2
    s_and_b32 s37, s37, 8
    s_mul_i32 s37, s37, 5
    s_xor_b32 s2, s2, s37
    s_bfe_u32 s37, s2, 0x20003
    s_mul_i32 s37, s37, 5632
    v_mul_u32_u24 v6, 11, v0
    v_add_u32 v6, s37, v6
    v_min_u32 v6, L_codeend-L_pc-4, v6
    global_load_ubyte v255, v6, s[42:43]
    v_and_b32 v1, 63, v0
    v_lshrrev_b32 v6, 6, v0
    v_and_b32 v3, 15, v1
    v_readfirstlane_b32 s30, v6
    v_mov_b32 v5, 0x20000
    v_lshl_add_u32 v6, v1, 2, v5
    v_mov_b32 v7, 0
    ds_write_b32 v6, v7 offset:15424
    v_lshrrev_b32 v2, 4, v1
    s_and_b32 s31, s2, 7
    s_lshr_b32 s32, s2, 4
    s_and_b32 s34, s2, 3
    s_bitcmp1_b32 s2, 3
    s_cbranch_scc1 L_PF
    s_cmp_lt_u32 s30, 4
    s_cbranch_scc1 L_PAA
    s_lshl_b32 s38, s31, 23
    s_lshl_b32 s39, s32, 16
    s_add_u32 s38, s38, s39
    s_add_u32 s38, s38, 7340032
    s_and_b32 s53, s30, 3
    s_lshr_b32 s37, s53, 1
    s_lshl2_add_u32 s53, s53, s37
    s_and_b32 s39, s30, 1
    s_lshl1_add_u32 s53, s39, s53
    s_lshl_b32 s39, s53, 16
    s_lshl_b32 s53, s53, 12
    s_add_u32 s38, s38, s53
    s_xor_b32 s38, s38, s39
    v_lshlrev_b32 v6, 1, v2
    v_xor_b32 v6, v6, v3
    v_lshlrev_b32 v6, 4, v6
    v_lshl_add_u32 v6, v2, 8, v6
    v_add_u32 v240, s38, v6
    v_xor_b32 v241, 0x80, v240
    v_xor_b32 v242, 0x11000, v240
    v_xor_b32 v243, 0x11080, v240
    s_waitcnt lgkmcnt(0)
    s_xor_b32 m0, s53, 0x0
    s_nop 0
    global_load_lds_dwordx4 v240, s[6:7] offset:0 nt
    global_load_lds_dwordx4 v241, s[6:7] offset:1024 nt
    global_load_lds_dwordx4 v240, s[6:7] offset:2048 nt
    global_load_lds_dwordx4 v241, s[6:7] offset:3072 nt
    s_xor_b32 m0, s53, 0x1000
    s_nop 0
    global_load_lds_dwordx4 v242, s[6:7] offset:0 nt
    global_load_lds_dwordx4 v243, s[6:7] offset:1024 nt
    s_load_dword s99, s[96:97], 0
    s_barrier
    s_branch L_BA
L_PAA:
    s_bfe_u32 s35, s2, 0x10002
    s_and_b32 s36, s32, 1
    s_lshl1_add_u32 s36, s35, s36
    s_lshl2_add_u32 s38, s34, s36
    s_lshr_b32 s33, s32, 1
    s_lshl_b32 s37, s33, 7
    v_lshrrev_b32 v6, 4, v0
    v_lshl_add_u32 v6, v6, 3, s37
    v_lshrrev_b32 v7, 3, v3
    v_lshlrev_b32 v16, 1, v6
    v_lshl_add_u32 v16, v7, 11, v16
    v_add_u32 v6, v6, v7
    v_lshlrev_b32 v6, 13, v6
    v_and_b32 v7, 7, v3
    v_lshl_add_u32 v6, v7, 4, v6
    s_lshl_b32 s37, s38, 9
    s_add_u32 s37, s37, 384
    v_add_u32 v212, s37, v6
    v_add_u32 v213, 0x4000, v212
    v_add_u32 v214, 0x8000, v212
    v_add_u32 v215, 0xc000, v212
    s_waitcnt lgkmcnt(0)
    global_load_dwordx4 v[208:211], v16, s[4:5]
    global_load_dwordx4 v[64:67], v212, s[10:11] nt
    global_load_dwordx4 v[68:71], v213, s[10:11] nt
    global_load_dwordx4 v[72:75], v214, s[10:11] nt
    global_load_dwordx4 v[76:79], v215, s[10:11] nt
    s_load_dword s99, s[96:97], 0
    s_barrier
    s_branch L_PAA2
L_PF:
    s_max_u32 s35, s32, 4
    s_sub_u32 s35, s35, 4
    s_mul_i32 s36, s35, 11
    s_lshr_b32 s36, s36, 5
    s_add_u32 s35, s35, s36
    s_lshr_b32 s33, s31, 2
    s_lshl4_add_u32 s36, s34, s35
    s_cmp_lt_u32 s32, 4
    s_cbranch_scc1 L_nw0
    s_lshl_b32 s37, s33, 8
    v_lshrrev_b32 v6, 4, v0
    v_lshl_add_u32 v6, v6, 3, s37
    v_lshrrev_b32 v7, 3, v3
    v_lshlrev_b32 v16, 1, v6
    v_lshl_add_u32 v16, v7, 11, v16
    v_add_u32 v6, v6, v7
    v_lshlrev_b32 v6, 13, v6
    v_and_b32 v7, 7, v3
    v_lshl_add_u32 v6, v7, 4, v6
    s_lshl_b32 s37, s36, 7
    v_add_u32 v17, s37, v6
    v_add_u32 v18, 0x4000, v17
    v_add_u32 v19, 0x8000, v17
    v_add_u32 v20, 0xc000, v17
    s_waitcnt lgkmcnt(0)
    s_add_u32 s48, s10, 0x400000
    s_addc_u32 s49, s11, 0
    global_load_dwordx4 v[24:27], v16, s[4:5]
    global_load_dwordx4 v[28:31], v16, s[4:5] offset:1024
    global_load_dwordx4 v[64:67], v17, s[10:11] nt
    global_load_dwordx4 v[68:71], v18, s[10:11] nt
    global_load_dwordx4 v[72:75], v19, s[10:11] nt
    global_load_dwordx4 v[76:79], v20, s[10:11] nt
    global_load_dwordx4 v[160:163], v17, s[48:49] nt
    global_load_dwordx4 v[164:167], v18, s[48:49] nt
    global_load_dwordx4 v[168:171], v19, s[48:49] nt
    global_load_dwordx4 v[172:175], v20, s[48:49] nt
L_nw0:
    s_waitcnt lgkmcnt(0)
    s_load_dword s99, s[96:97], 0
    s_barrier
    s_movk_i32 s44, 0xff
    s_mov_b32 s46, 0x00ff00ff
    s_mov_b32 s47, 0x00ff00ff
    v_lshlrev_b32 v6, 4, v1
    v_mov_b32 v16, 0x0d0c
    v_mov_b32 v17, 0
    v_lshlrev_b64 v[18:19], v6, v[16:17]
    v_mov_b32 v16, 0x0f0e
    v_lshlrev_b64 v[20:21], v6, v[16:17]
    v_bfe_i32 v7, v1, 2, 1
    v_mov_b32 v22, 0x0c0c0c0c
    v_bitop3_b32 v8, v18, v7, v22 bitop3:0x9a
    v_bitop3_b32 v9, v19, v7, v22 bitop3:0x9a
    v_bitop3_b32 v10, v18, v7, v22 bitop3:0x6a
    v_bitop3_b32 v11, v19, v7, v22 bitop3:0x6a
    v_bitop3_b32 v12, v20, v7, v22 bitop3:0x9a
    v_bitop3_b32 v13, v21, v7, v22 bitop3:0x9a
    v_bitop3_b32 v14, v20, v7, v22 bitop3:0x6a
    v_bitop3_b32 v15, v21, v7, v22 bitop3:0x6a
    s_and_b32 s37, s36, 3
    s_lshl2_add_u32 s39, s33, s37
    s_lshr_b32 s38, s36, 2
    s_mul_i32 s37, s38, 2
    s_lshr_b32 s45, s39, 3
    s_add_u32 s37, s37, s45
    s_lshl_b32 s37, s37, 7
    s_and_b32 s45, s39, 7
    s_add_u32 s37, s37, s45
    s_add_u32 s37, s37, 5242880
    v_and_b32 v6, 7, v1
    v_mul_u32_u24 v6, 4096, v6
    v_add_u32 v91, s37, v6
    s_mul_i32 s38, s38, 3584
    s_lshl_b32 s39, s39, 8
    s_add_u32 s38, s38, s39
    s_add_u32 s38, s38, 65536
    v_lshrrev_b32 v6, 1, v2
    v_mul_u32_u24 v88, 57344, v6
    v_and_b32 v7, 1, v2
    v_lshl_add_u32 v88, v7, 4, v88
    v_and_b32 v7, 7, v3
    v_lshl_add_u32 v88, v7, 5, v88
    v_add_u32 v88, s38, v88
    v_lshl_add_u32 v6, v2, 3, v7
    v_lshl_add_u32 v6, v6, 4, v5
    s_lshl_b32 s38, s30, 9
    v_add_u32 v89, s38, v6
    v_lshrrev_b32 v7, 3, v3
    v_lshl_add_u32 v90, v7, 11, v6
    v_and_b32 v6, 7, v1
    v_lshl_add_u32 v93, v6, 2, v5
    s_lshl_b32 s38, s30, 2
    v_add_u32 v92, s38, v5
    s_mul_i32 s37, s31, 10
    s_add_u32 s37, s37, s32
    s_sub_u32 s37, s37, 4
    s_lshr_b32 s38, s37, 2
    s_add_u32 s38, s38, 2
    s_mul_i32 s38, s38, 43
    s_lshr_b32 s38, s38, 7
    s_lshl2_add_u32 s28, s38, s37
    s_lshl4_add_u32 s37, s31, 4
    s_min_u32 s37, s37, 108
    s_add_u32 s37, s37, s32
    s_cmp_ge_u32 s32, 14
    s_cselect_b32 s29, 1, 0
    s_cmp_lt_u32 s32, 4
    s_cselect_b32 s28, s37, s28
    s_cselect_b32 s29, 2, s29
    s_waitcnt lgkmcnt(0)
    s_add_u32 s99, s99, 1
    v_mov_b32 v4, s99
    s_and_b32 s58, s99, 0xff
    s_mul_i32 s58, s58, 0x01010101
    s_mov_b32 s59, s58
    s_cmp_ge_u32 s30, 4
    s_cbranch_scc1 L_BF
    v_mov_b32 v138, v92
    s_and_b32 s57, s30, 1
    s_lshl_b32 s39, s57, 11
    v_lshlrev_b32 v17, 5, v1
    v_add_u32 v18, s39, v17
    s_cmp_lt_u32 s30, 2
    s_cbranch_scc1 L_noglf
    global_load_dwordx4 v[224:227], v18, s[4:5]
    global_load_dwordx4 v[228:231], v18, s[4:5] offset:16
    global_load_dwordx4 v[232:235], v17, s[22:23]
    global_load_dwordx4 v[236:239], v17, s[22:23] offset:16
    s_branch L_gldf
L_noglf:
    v_and_b32 v6, 3, v1
    v_lshlrev_b32 v6, 21, v6
    s_mov_b64 exec, 7
    global_load_dword v252, v6, s[96:97] sc1
    global_load_dword v251, v1, s[24:25]
    global_load_dword v250, v1, s[4:5]
    global_load_dword v249, v1, s[4:5]
    s_mov_b64 exec, -1
L_gldf:
    s_cmp_eq_u32 s29, 2
    s_cbranch_scc1 L_nw1
    s_waitcnt vmcnt(12)
    v_perm_b32 v32, v24, v24, v8
    v_perm_b32 v33, v24, v24, v9
    v_perm_b32 v34, v24, v24, v10
    v_perm_b32 v35, v24, v24, v11
    v_perm_b32 v36, v24, v24, v12
    v_perm_b32 v37, v24, v24, v13
    v_perm_b32 v38, v24, v24, v14
    v_perm_b32 v39, v24, v24, v15
    v_perm_b32 v40, v25, v25, v8
    v_perm_b32 v41, v25, v25, v9
    v_perm_b32 v42, v25, v25, v10
    v_perm_b32 v43, v25, v25, v11
    v_perm_b32 v44, v25, v25, v12
    v_perm_b32 v45, v25, v25, v13
    v_perm_b32 v46, v25, v25, v14
    v_perm_b32 v47, v25, v25, v15
    v_perm_b32 v48, v26, v26, v8
    v_perm_b32 v49, v26, v26, v9
    v_perm_b32 v50, v26, v26, v10
    v_perm_b32 v51, v26, v26, v11
    v_perm_b32 v52, v26, v26, v12
    v_perm_b32 v53, v26, v26, v13
    v_perm_b32 v54, v26, v26, v14
    v_perm_b32 v55, v26, v26, v15
    v_perm_b32 v56, v27, v27, v8
    v_perm_b32 v57, v27, v27, v9
    v_perm_b32 v58, v27, v27, v10
    v_perm_b32 v59, v27, v27, v11
    v_perm_b32 v60, v27, v27, v12
    v_perm_b32 v61, v27, v27, v13
    v_perm_b32 v62, v27, v27, v14
    v_perm_b32 v63, v27, v27, v15
    v_perm_b32 v176, v28, v28, v8
    v_perm_b32 v177, v28, v28, v9
    v_perm_b32 v178, v28, v28, v10
    v_perm_b32 v179, v28, v28, v11
    v_perm_b32 v180, v28, v28, v12
    v_perm_b32 v181, v28, v28, v13
    v_perm_b32 v182, v28, v28, v14
    v_perm_b32 v183, v28, v28, v15
    v_perm_b32 v184, v29, v29, v8
    v_perm_b32 v185, v29, v29, v9
    v_perm_b32 v186, v29, v29, v10
    v_perm_b32 v187, v29, v29, v11
    v_perm_b32 v188, v29, v29, v12
    v_perm_b32 v189, v29, v29, v13
    v_perm_b32 v190, v29, v29, v14
    v_perm_b32 v191, v29, v29, v15
    v_perm_b32 v192, v30, v30, v8
    v_perm_b32 v193, v30, v30, v9
    v_perm_b32 v194, v30, v30, v10
    v_perm_b32 v195, v30, v30, v11
    v_perm_b32 v196, v30, v30, v12
    v_perm_b32 v197, v30, v30, v13
    v_perm_b32 v198, v30, v30, v14
    v_perm_b32 v199, v30, v30, v15
    v_perm_b32 v200, v31, v31, v8
    v_perm_b32 v201, v31, v31, v9
    v_perm_b32 v202, v31, v31, v10
    v_perm_b32 v203, v31, v31, v11
    v_perm_b32 v204, v31, v31, v12
    v_perm_b32 v205, v31, v31, v13
    v_perm_b32 v206, v31, v31, v14
    v_perm_b32 v207, v31, v31, v15
    s_waitcnt vmcnt(11)
    v_mfma_f32_16x16x32_bf16 v[80:83], v[32:35], v[64:67], 0
    v_mfma_f32_16x16x32_bf16 v[84:87], v[36:39], v[64:67], 0
    s_waitcnt vmcnt(10)
    v_mfma_f32_16x16x32_bf16 v[80:83], v[40:43], v[68:71], v[80:83]
    v_mfma_f32_16x16x32_bf16 v[84:87], v[44:47], v[68:71], v[84:87]
    s_waitcnt vmcnt(9)
    v_mfma_f32_16x16x32_bf16 v[80:83], v[48:51], v[72:75], v[80:83]
    v_mfma_f32_16x16x32_bf16 v[84:87], v[52:55], v[72:75], v[84:87]
    s_waitcnt vmcnt(8)
    v_mfma_f32_16x16x32_bf16 v[80:83], v[56:59], v[76:79], v[80:83]
    v_mfma_f32_16x16x32_bf16 v[84:87], v[60:63], v[76:79], v[84:87]
    s_waitcnt vmcnt(7)
    v_mfma_f32_16x16x32_bf16 v[80:83], v[176:179], v[160:163], v[80:83]
    v_mfma_f32_16x16x32_bf16 v[84:87], v[180:183], v[160:163], v[84:87]
    s_waitcnt vmcnt(6)
    v_mfma_f32_16x16x32_bf16 v[80:83], v[184:187], v[164:167], v[80:83]
    v_mfma_f32_16x16x32_bf16 v[84:87], v[188:191], v[164:167], v[84:87]
    s_waitcnt vmcnt(5)
    v_mfma_f32_16x16x32_bf16 v[80:83], v[192:195], v[168:171], v[80:83]
    v_mfma_f32_16x16x32_bf16 v[84:87], v[196:199], v[168:171], v[84:87]
    s_waitcnt vmcnt(4)
    v_mfma_f32_16x16x32_bf16 v[80:83], v[200:203], v[172:175], v[80:83]
    v_mfma_f32_16x16x32_bf16 v[84:87], v[204:207], v[172:175], v[84:87]
    v_mov_b32 v7, 1
    s_nop 6
    v_add_f32_dpp v80, v84, v80 row_ror:8 row_mask:0xf bank_mask:0xf
    v_add_f32_dpp v81, v85, v81 row_ror:8 row_mask:0xf bank_mask:0xf
    v_add_f32_dpp v82, v86, v82 row_ror:8 row_mask:0xf bank_mask:0xf
    v_add_f32_dpp v83, v87, v83 row_ror:8 row_mask:0xf bank_mask:0xf
    s_mov_b64 exec, s[46:47]
    ds_write_b128 v89, v[80:83] offset:8192
    s_mov_b64 exec, -1
    ds_write_b32 v92, v7 offset:15552
    s_cmp_lg_u32 s30, 0
    s_cbranch_scc1 L_noqpubA
    s_mov_b32 s40, 200000
Llw_1:
    ds_read_b32 v16, v93 offset:15552
    ds_read_b128 v[64:67], v90 offset:8192
    ds_read_b128 v[68:71], v90 offset:8704
    ds_read_b128 v[72:75], v90 offset:9216
    ds_read_b128 v[76:79], v90 offset:9728
    s_waitcnt lgkmcnt(4)
    v_cmp_eq_u32 vcc, 0, v16
    s_cbranch_vccz Llwd_2
    s_sub_u32 s40, s40, 1
    s_cbranch_scc0 Llw_1
Llwd_2:
    s_waitcnt lgkmcnt(0)
    v_pk_add_f32 v[64:65], v[64:65], v[68:69]
    v_pk_add_f32 v[66:67], v[66:67], v[70:71]
    v_pk_add_f32 v[72:73], v[72:73], v[76:77]
    v_pk_add_f32 v[74:75], v[74:75], v[78:79]
    v_pk_add_f32 v[64:65], v[64:65], v[72:73]
    v_pk_add_f32 v[66:67], v[66:67], v[74:75]
    s_nop 0
    v_add_f32_dpp v64, v64, v64 row_ror:8 row_mask:0xf bank_mask:0xf
    v_add_f32_dpp v65, v65, v65 row_ror:8 row_mask:0xf bank_mask:0xf
    v_add_f32_dpp v66, v66, v66 row_ror:8 row_mask:0xf bank_mask:0xf
    v_add_f32_dpp v67, v67, v67 row_ror:8 row_mask:0xf bank_mask:0xf
    s_mov_b64 exec, s[46:47]
    v_bfi_b32 v64, s44, v4, v64
    v_bfi_b32 v65, s44, v4, v65
    v_bfi_b32 v66, s44, v4, v66
    v_bfi_b32 v67, s44, v4, v67
    global_store_dwordx4 v88, v[64:67], s[96:97] sc1
    s_mov_b64 exec, 0xff
    global_store_byte v91, v4, s[96:97] sc1
    s_mov_b64 exec, -1
    s_mov_b64 exec, -1
L_noqpubA:
L_nw1:
    s_cmp_eq_u32 s29, 1
    s_cbranch_scc1 L_fin
    s_cmp_lt_u32 s30, 2
    s_cbranch_scc1 L_nogf
    v_mov_b32 v20, 0
    v_mov_b32 v21, 0x3f803f80
    s_waitcnt vmcnt(0)
    v_lshlrev_b32 v16, 16, v224
    v_and_b32 v17, 0xffff0000, v224
    v_lshlrev_b32 v18, 16, v232
    v_and_b32 v19, 0xffff0000, v232
    v_pk_mul_f32 v[16:17], v[16:17], v[18:19]
    v_cvt_pk_bf16_f32 v224, v16, v17
    v_lshlrev_b32 v16, 16, v225
    v_and_b32 v17, 0xffff0000, v225
    v_lshlrev_b32 v18, 16, v233
    v_and_b32 v19, 0xffff0000, v233
    v_pk_mul_f32 v[16:17], v[16:17], v[18:19]
    v_cvt_pk_bf16_f32 v225, v16, v17
    v_lshlrev_b32 v16, 16, v226
    v_and_b32 v17, 0xffff0000, v226
    v_lshlrev_b32 v18, 16, v234
    v_and_b32 v19, 0xffff0000, v234
    v_pk_mul_f32 v[16:17], v[16:17], v[18:19]
    v_cvt_pk_bf16_f32 v226, v16, v17
    v_lshlrev_b32 v16, 16, v227
    v_and_b32 v17, 0xffff0000, v227
    v_lshlrev_b32 v18, 16, v235
    v_and_b32 v19, 0xffff0000, v235
    v_pk_mul_f32 v[16:17], v[16:17], v[18:19]
    v_cvt_pk_bf16_f32 v227, v16, v17
    v_lshlrev_b32 v16, 16, v228
    v_and_b32 v17, 0xffff0000, v228
    v_lshlrev_b32 v18, 16, v236
    v_and_b32 v19, 0xffff0000, v236
    v_pk_mul_f32 v[16:17], v[16:17], v[18:19]
    v_cvt_pk_bf16_f32 v228, v16, v17
    v_lshlrev_b32 v16, 16, v229
    v_and_b32 v17, 0xffff0000, v229
    v_lshlrev_b32 v18, 16, v237
    v_and_b32 v19, 0xffff0000, v237
    v_pk_mul_f32 v[16:17], v[16:17], v[18:19]
    v_cvt_pk_bf16_f32 v229, v16, v17
    v_lshlrev_b32 v16, 16, v230
    v_and_b32 v17, 0xffff0000, v230
    v_lshlrev_b32 v18, 16, v238
    v_and_b32 v19, 0xffff0000, v238
    v_pk_mul_f32 v[16:17], v[16:17], v[18:19]
    v_cvt_pk_bf16_f32 v230, v16, v17
    v_lshlrev_b32 v16, 16, v231
    v_and_b32 v17, 0xffff0000, v231
    v_lshlrev_b32 v18, 16, v239
    v_and_b32 v19, 0xffff0000, v239
    v_pk_mul_f32 v[16:17], v[16:17], v[18:19]
    v_cvt_pk_bf16_f32 v231, v16, v17
    v_dot2_f32_bf16 v20, v224, v21, v20
    v_dot2_f32_bf16 v20, v225, v21, v20
    v_dot2_f32_bf16 v20, v226, v21, v20
    v_dot2_f32_bf16 v20, v227, v21, v20
    v_dot2_f32_bf16 v20, v228, v21, v20
    v_dot2_f32_bf16 v20, v229, v21, v20
    v_dot2_f32_bf16 v20, v230, v21, v20
    v_dot2_f32_bf16 v20, v231, v21, v20
    s_nop 2
    v_add_f32_dpp v20, v20, v20 row_ror:1 row_mask:0xf bank_mask:0xf
    s_nop 1
    v_add_f32_dpp v20, v20, v20 row_ror:2 row_mask:0xf bank_mask:0xf
    s_nop 1
    v_add_f32_dpp v20, v20, v20 row_ror:4 row_mask:0xf bank_mask:0xf
    s_nop 1
    v_add_f32_dpp v20, v20, v20 row_ror:8 row_mask:0xf bank_mask:0xf
    v_mov_b32 v16, v20
    s_nop 1
    v_permlane16_swap_b32 v16, v20
    v_add_f32 v20, v20, v16
    v_mov_b32 v16, v20
    s_nop 1
    v_permlane32_swap_b32 v16, v20
    v_add_f32 v20, v20, v16
    v_cvt_pk_bf16_f32 v20, v20, v20
    v_and_b32 v20, 0xffff0000, v20
    v_mul_f32 v20, 0xbfb8aa3b, v20
    v_exp_f32 v20, v20
    s_nop 0
    v_add_f32 v20, 1.0, v20
    v_rcp_f32 v20, v20
    s_nop 0
    v_cvt_pk_bf16_f32 v20, v20, v20
    v_and_b32 v20, 0xffff0000, v20
    v_sub_f32 v21, 1.0, v20
    v_cvt_pk_bf16_f32 v21, v21, v21
    v_and_b32 v21, 0xffff0000, v21
    s_lshl_b32 s38, s57, 3
    v_add_u32 v16, s38, v5
    ds_write_b64 v16, v[20:21] offset:15360
L_nogf:
    s_branch L_AF
L_PAA2:
    s_lshl4_add_u32 s28, s35, s32
    s_mov_b32 s35, s38
    s_and_b32 s57, s30, 1
    s_lshl_b32 s39, s57, 11
    v_lshlrev_b32 v17, 5, v1
    v_add_u32 v18, s39, v17
    s_cmp_lt_u32 s30, 2
    s_cbranch_scc1 L_nogla
    global_load_dwordx4 v[224:227], v18, s[4:5]
    global_load_dwordx4 v[228:231], v18, s[4:5] offset:16
    global_load_dwordx4 v[232:235], v17, s[22:23]
    global_load_dwordx4 v[236:239], v17, s[22:23] offset:16
    s_branch L_glda
L_nogla:
    v_and_b32 v6, 3, v1
    v_lshlrev_b32 v6, 21, v6
    s_mov_b64 exec, 7
    global_load_dword v252, v6, s[96:97] sc1
    global_load_dword v251, v1, s[24:25]
    global_load_dword v250, v1, s[4:5]
    global_load_dword v249, v1, s[4:5]
    s_mov_b64 exec, -1
L_glda:
    s_movk_i32 s44, 0xff
    s_mov_b32 s46, 0x00ff00ff
    s_mov_b32 s47, 0x00ff00ff
    v_lshlrev_b32 v6, 4, v1
    v_mov_b32 v16, 0x0d0c
    v_mov_b32 v17, 0
    v_lshlrev_b64 v[18:19], v6, v[16:17]
    v_mov_b32 v16, 0x0f0e
    v_lshlrev_b64 v[20:21], v6, v[16:17]
    v_bfe_i32 v7, v1, 2, 1
    v_mov_b32 v22, 0x0c0c0c0c
    v_bitop3_b32 v8, v18, v7, v22 bitop3:0x9a
    v_bitop3_b32 v9, v19, v7, v22 bitop3:0x9a
    v_bitop3_b32 v10, v18, v7, v22 bitop3:0x6a
    v_bitop3_b32 v11, v19, v7, v22 bitop3:0x6a
    v_bitop3_b32 v12, v20, v7, v22 bitop3:0x9a
    v_bitop3_b32 v13, v21, v7, v22 bitop3:0x9a
    v_bitop3_b32 v14, v20, v7, v22 bitop3:0x6a
    v_bitop3_b32 v15, v21, v7, v22 bitop3:0x6a
    s_mov_b32 s38, s35
    s_lshl2_add_u32 s39, s33, 3
    s_add_u32 s37, s33, 6
    s_cmp_ge_u32 s33, 2
    s_cselect_b32 s39, s37, s39
    s_mul_i32 s37, s38, 2
    s_lshr_b32 s45, s39, 3
    s_add_u32 s37, s37, s45
    s_lshl_b32 s37, s37, 7
    s_and_b32 s45, s39, 7
    s_add_u32 s37, s37, s45
    s_add_u32 s37, s37, 5242880
    v_and_b32 v6, 7, v1
    v_mul_u32_u24 v6, 4096, v6
    v_add_u32 v91, s37, v6
    s_mul_i32 s38, s38, 3584
    s_lshl_b32 s39, s39, 8
    s_add_u32 s38, s38, s39
    s_add_u32 s38, s38, 65536
    v_lshrrev_b32 v6, 1, v2
    v_mul_u32_u24 v88, 57344, v6
    v_and_b32 v7, 1, v2
    v_lshl_add_u32 v88, v7, 4, v88
    v_and_b32 v7, 7, v3
    v_lshl_add_u32 v88, v7, 5, v88
    v_add_u32 v88, s38, v88
    v_lshl_add_u32 v6, v2, 3, v7
    v_lshl_add_u32 v6, v6, 4, v5
    s_lshl_b32 s38, s30, 9
    v_add_u32 v89, s38, v6
    s_lshl_b32 s38, s31, 2
    s_add_u32 s38, s38, s30
    s_mul_i32 s38, s38, 3584
    s_add_u32 s38, s38, 65536
    v_lshlrev_b32 v137, 4, v1
    v_add_u32 v137, s38, v137
    s_lshr_b32 s45, s2, 5
    s_lshl_b32 s45, s45, 2
    s_or_b32 s45, s45, s34
    s_lshl_b32 s45, s45, 2
    s_add_u32 s45, s45, s30
    s_mul_i32 s56, s45, 256
    s_add_u32 s56, s56, 5242880
    v_and_b32 v6, 7, v3
    v_lshlrev_b32 v6, 1, v6
    v_xor_b32 v6, v6, v2
    v_lshlrev_b32 v6, 4, v6
    v_lshl_add_u32 v6, v3, 8, v6
    s_lshl_b32 s38, s30, 14
    v_add_u32 v140, s38, v6
    v_xor_b32 v141, 64, v140
    v_xor_b32 v142, 0x80, v140
    v_xor_b32 v143, 0xc0, v140
    s_lshl_b32 s38, s30, 2
    v_add_u32 v138, s38, v5
    v_add_u32 v92, s38, v5
    s_waitcnt lgkmcnt(0)
    s_add_u32 s99, s99, 1
    v_mov_b32 v4, s99
    s_and_b32 s58, s99, 0xff
    s_mul_i32 s58, s58, 0x01010101
    s_mov_b32 s59, s58
    s_waitcnt vmcnt(8)
    v_perm_b32 v32, v208, v208, v8
    v_perm_b32 v33, v208, v208, v9
    v_perm_b32 v34, v208, v208, v10
    v_perm_b32 v35, v208, v208, v11
    v_perm_b32 v36, v208, v208, v12
    v_perm_b32 v37, v208, v208, v13
    v_perm_b32 v38, v208, v208, v14
    v_perm_b32 v39, v208, v208, v15
    v_perm_b32 v40, v209, v209, v8
    v_perm_b32 v41, v209, v209, v9
    v_perm_b32 v42, v209, v209, v10
    v_perm_b32 v43, v209, v209, v11
    v_perm_b32 v44, v209, v209, v12
    v_perm_b32 v45, v209, v209, v13
    v_perm_b32 v46, v209, v209, v14
    v_perm_b32 v47, v209, v209, v15
    v_perm_b32 v48, v210, v210, v8
    v_perm_b32 v49, v210, v210, v9
    v_perm_b32 v50, v210, v210, v10
    v_perm_b32 v51, v210, v210, v11
    v_perm_b32 v52, v210, v210, v12
    v_perm_b32 v53, v210, v210, v13
    v_perm_b32 v54, v210, v210, v14
    v_perm_b32 v55, v210, v210, v15
    v_perm_b32 v56, v211, v211, v8
    v_perm_b32 v57, v211, v211, v9
    v_perm_b32 v58, v211, v211, v10
    v_perm_b32 v59, v211, v211, v11
    v_perm_b32 v60, v211, v211, v12
    v_perm_b32 v61, v211, v211, v13
    v_perm_b32 v62, v211, v211, v14
    v_perm_b32 v63, v211, v211, v15
    s_waitcnt vmcnt(7)
    v_mfma_f32_16x16x32_bf16 v[80:83], v[32:35], v[64:67], 0
    v_mfma_f32_16x16x32_bf16 v[84:87], v[36:39], v[64:67], 0
    s_waitcnt vmcnt(6)
    v_mfma_f32_16x16x32_bf16 v[80:83], v[40:43], v[68:71], v[80:83]
    v_mfma_f32_16x16x32_bf16 v[84:87], v[44:47], v[68:71], v[84:87]
    s_waitcnt vmcnt(5)
    v_mfma_f32_16x16x32_bf16 v[80:83], v[48:51], v[72:75], v[80:83]
    v_mfma_f32_16x16x32_bf16 v[84:87], v[52:55], v[72:75], v[84:87]
    s_waitcnt vmcnt(4)
    v_mfma_f32_16x16x32_bf16 v[80:83], v[56:59], v[76:79], v[80:83]
    v_mfma_f32_16x16x32_bf16 v[84:87], v[60:63], v[76:79], v[84:87]
    v_mov_b32 v7, 1
    s_nop 6
    v_add_f32_dpp v80, v84, v80 row_ror:8 row_mask:0xf bank_mask:0xf
    v_add_f32_dpp v81, v85, v81 row_ror:8 row_mask:0xf bank_mask:0xf
    v_add_f32_dpp v82, v86, v82 row_ror:8 row_mask:0xf bank_mask:0xf
    v_add_f32_dpp v83, v87, v83 row_ror:8 row_mask:0xf bank_mask:0xf
    s_mov_b64 exec, s[46:47]
    ds_write_b128 v89, v[80:83] offset:8192
    s_mov_b64 exec, -1
    ds_write_b32 v92, v7 offset:15552
    s_cmp_lg_u32 s30, 0
    s_cbranch_scc1 L_noqpubS
    s_mov_b32 s40, 200000
Llw_3:
    ds_read_b128 v[16:19], v5 offset:15552
    ds_read_b128 v[64:67], v89 offset:8192
    ds_read_b128 v[68:71], v89 offset:8704
    ds_read_b128 v[72:75], v89 offset:9216
    ds_read_b128 v[76:79], v89 offset:9728
    s_waitcnt lgkmcnt(4)
    v_bitop3_b32 v16, v16, v17, v18 bitop3:0x80
    v_and_b32 v16, v16, v19
    v_cmp_eq_u32 vcc, 0, v16
    s_cbranch_vccz Llwd_4
    s_sub_u32 s40, s40, 1
    s_cbranch_scc0 Llw_3
Llwd_4:
    s_waitcnt lgkmcnt(0)
    v_pk_add_f32 v[64:65], v[64:65], v[68:69]
    v_pk_add_f32 v[66:67], v[66:67], v[70:71]
    v_pk_add_f32 v[72:73], v[72:73], v[76:77]
    v_pk_add_f32 v[74:75], v[74:75], v[78:79]
    v_pk_add_f32 v[64:65], v[64:65], v[72:73]
    v_pk_add_f32 v[66:67], v[66:67], v[74:75]
    s_mov_b64 exec, s[46:47]
    v_bfi_b32 v64, s44, v4, v64
    v_bfi_b32 v65, s44, v4, v65
    v_bfi_b32 v66, s44, v4, v66
    v_bfi_b32 v67, s44, v4, v67
    global_store_dwordx4 v88, v[64:67], s[96:97] sc1
    s_mov_b64 exec, 0xff
    global_store_byte v91, v4, s[96:97] sc1
    s_mov_b64 exec, -1
    s_mov_b64 exec, -1
L_noqpubS:
    s_cmp_lt_u32 s30, 2
    s_cbranch_scc1 L_noga
    v_mov_b32 v20, 0
    v_mov_b32 v21, 0x3f803f80
    s_waitcnt vmcnt(0)
    v_lshlrev_b32 v16, 16, v224
    v_and_b32 v17, 0xffff0000, v224
    v_lshlrev_b32 v18, 16, v232
    v_and_b32 v19, 0xffff0000, v232
    v_pk_mul_f32 v[16:17], v[16:17], v[18:19]
    v_cvt_pk_bf16_f32 v224, v16, v17
    v_lshlrev_b32 v16, 16, v225
    v_and_b32 v17, 0xffff0000, v225
    v_lshlrev_b32 v18, 16, v233
    v_and_b32 v19, 0xffff0000, v233
    v_pk_mul_f32 v[16:17], v[16:17], v[18:19]
    v_cvt_pk_bf16_f32 v225, v16, v17
    v_lshlrev_b32 v16, 16, v226
    v_and_b32 v17, 0xffff0000, v226
    v_lshlrev_b32 v18, 16, v234
    v_and_b32 v19, 0xffff0000, v234
    v_pk_mul_f32 v[16:17], v[16:17], v[18:19]
    v_cvt_pk_bf16_f32 v226, v16, v17
    v_lshlrev_b32 v16, 16, v227
    v_and_b32 v17, 0xffff0000, v227
    v_lshlrev_b32 v18, 16, v235
    v_and_b32 v19, 0xffff0000, v235
    v_pk_mul_f32 v[16:17], v[16:17], v[18:19]
    v_cvt_pk_bf16_f32 v227, v16, v17
    v_lshlrev_b32 v16, 16, v228
    v_and_b32 v17, 0xffff0000, v228
    v_lshlrev_b32 v18, 16, v236
    v_and_b32 v19, 0xffff0000, v236
    v_pk_mul_f32 v[16:17], v[16:17], v[18:19]
    v_cvt_pk_bf16_f32 v228, v16, v17
    v_lshlrev_b32 v16, 16, v229
    v_and_b32 v17, 0xffff0000, v229
    v_lshlrev_b32 v18, 16, v237
    v_and_b32 v19, 0xffff0000, v237
    v_pk_mul_f32 v[16:17], v[16:17], v[18:19]
    v_cvt_pk_bf16_f32 v229, v16, v17
    v_lshlrev_b32 v16, 16, v230
    v_and_b32 v17, 0xffff0000, v230
    v_lshlrev_b32 v18, 16, v238
    v_and_b32 v19, 0xffff0000, v238
    v_pk_mul_f32 v[16:17], v[16:17], v[18:19]
    v_cvt_pk_bf16_f32 v230, v16, v17
    v_lshlrev_b32 v16, 16, v231
    v_and_b32 v17, 0xffff0000, v231
    v_lshlrev_b32 v18, 16, v239
    v_and_b32 v19, 0xffff0000, v239
    v_pk_mul_f32 v[16:17], v[16:17], v[18:19]
    v_cvt_pk_bf16_f32 v231, v16, v17
    v_dot2_f32_bf16 v20, v224, v21, v20
    v_dot2_f32_bf16 v20, v225, v21, v20
    v_dot2_f32_bf16 v20, v226, v21, v20
    v_dot2_f32_bf16 v20, v227, v21, v20
    v_dot2_f32_bf16 v20, v228, v21, v20
    v_dot2_f32_bf16 v20, v229, v21, v20
    v_dot2_f32_bf16 v20, v230, v21, v20
    v_dot2_f32_bf16 v20, v231, v21, v20
    s_nop 2
    v_add_f32_dpp v20, v20, v20 row_ror:1 row_mask:0xf bank_mask:0xf
    s_nop 1
    v_add_f32_dpp v20, v20, v20 row_ror:2 row_mask:0xf bank_mask:0xf
    s_nop 1
    v_add_f32_dpp v20, v20, v20 row_ror:4 row_mask:0xf bank_mask:0xf
    s_nop 1
    v_add_f32_dpp v20, v20, v20 row_ror:8 row_mask:0xf bank_mask:0xf
    v_mov_b32 v16, v20
    s_nop 1
    v_permlane16_swap_b32 v16, v20
    v_add_f32 v20, v20, v16
    v_mov_b32 v16, v20
    s_nop 1
    v_permlane32_swap_b32 v16, v20
    v_add_f32 v20, v20, v16
    v_cvt_pk_bf16_f32 v20, v20, v20
    v_and_b32 v20, 0xffff0000, v20
    v_mul_f32 v20, 0xbfb8aa3b, v20
    v_exp_f32 v20, v20
    s_nop 0
    v_add_f32 v20, 1.0, v20
    v_rcp_f32 v20, v20
    s_nop 0
    v_cvt_pk_bf16_f32 v20, v20, v20
    v_and_b32 v20, 0xffff0000, v20
    v_sub_f32 v21, 1.0, v20
    v_cvt_pk_bf16_f32 v21, v21, v21
    v_and_b32 v21, 0xffff0000, v21
    s_lshl_b32 s38, s57, 3
    v_add_u32 v16, s38, v5
    ds_write_b64 v16, v[20:21] offset:15360
L_noga:
    v_lshrrev_b32 v6, 5, v1
    v_mul_u32_u24 v6, 272, v6
    v_and_b32 v7, 31, v1
    v_lshl_add_u32 v6, v7, 3, v6
    s_mul_i32 s38, s30, 544
    v_add3_u32 v24, v6, s38, v5
    v_and_b32 v22, 7, v3
    v_lshrrev_b32 v23, 3, v3
    v_mul_u32_u24 v6, 272, v22
    v_lshl_add_u32 v6, v2, 4, v6
    v_add_u32 v25, v6, v5
    v_lshrrev_b32 v6, 2, v1
    v_and_b32 v7, 7, v6
    s_lshl_b32 s38, s30, 1
    v_xor_b32 v7, s38, v7
    v_lshlrev_b32 v7, 5, v7
    v_and_b32 v16, 3, v1
    v_lshl_add_u32 v7, v16, 3, v7
    v_lshl_add_u32 v7, v6, 8, v7
    v_add_u32 v144, 0x10000, v7
    v_xor_b32 v145, 32, v144
    v_lshl_add_u32 v6, v2, 3, v22
    v_lshl_add_u32 v27, v6, 4, v5
    s_lshl_b32 s38, s30, 10
    v_lshl_add_u32 v6, v23, 9, s38
    v_add_u32 v26, v6, v27
    v_lshl_add_u32 v29, v3, 3, v5
    s_lshl_b32 s38, s30, 7
    v_add_u32 v28, s38, v29
    s_lshr_b32 s37, s31, 2
    s_lshl_b32 s38, s34, 17
    s_lshl_b32 s39, s30, 12
    s_add_u32 s38, s38, s39
    s_lshl_b32 s39, s28, 7
    s_add_u32 s38, s38, s39
    s_add_u32 s38, s38, 1048576
    v_lshlrev_b32 v6, 14, v22
    v_lshl_add_u32 v6, v23, 6, v6
    v_lshl_add_u32 v6, v2, 4, v6
    v_add_u32 v30, s38, v6
    s_lshl_b32 s38, s34, 12
    s_lshl_b32 s39, s28, 4
    s_add_u32 s38, s38, s39
    s_add_u32 s38, s38, 262144
    v_lshl_add_u32 v31, v22, 9, s38
    s_lshl2_add_u32 s38, s31, s30
    s_mul_i32 s38, s38, 8
    s_lshr_b32 s39, s32, 3
    s_add_u32 s38, s38, s39
    s_lshl_b32 s38, s38, 7
    s_and_b32 s39, s32, 7
    s_add_u32 s38, s38, s39
    s_add_u32 s38, s38, 4718592
    v_mul_u32_u24 v6, 256, v3
    v_add_u32 v146, s38, v6
    s_lshr_b32 s37, s28, 2
    s_lshl3_add_u32 s36, s34, s37
    s_lshr_b32 s35, s30, 1
    s_and_b32 s33, s28, 2
    s_add_u32 s33, s33, s35
    s_lshl2_add_u32 s38, s36, s33
    s_lshl1_add_u32 s38, s38, s57
    s_lshl_b32 s38, s38, 11
    s_add_u32 s38, s38, 1048576
    v_lshl_add_u32 v148, v1, 4, s38
    s_lshl1_add_u32 s38, s36, s57
    s_lshl_b32 s38, s38, 8
    s_add_u32 s38, s38, 262144
    v_lshrrev_b32 v6, 3, v1
    v_lshl_add_u32 v149, v6, 4, s38
    s_lshl2_add_u32 s38, s57, s34
    s_lshl2_add_u32 s38, s38, s33
    s_mul_i32 s38, s38, 4
    s_and_b32 s39, s28, 1
    s_lshl1_add_u32 s39, s37, s39
    s_and_b32 s39, s39, 3
    s_add_u32 s38, s38, s39
    s_mul_i32 s98, s38, 256
    s_add_u32 s98, s98, 4718592
    v_and_b32 v16, 1, v2
    v_lshlrev_b32 v16, 1, v16
    v_lshrrev_b32 v17, 1, v2
    v_or_b32 v21, v16, v17
    v_lshlrev_b32 v17, 1, v22
    v_lshl_add_u32 v17, v21, 5, v17
    s_lshl_b32 s38, s57, 7
    s_lshl_b32 s39, s35, 4
    s_add_u32 s38, s38, s39
    v_add3_u32 v150, v17, s38, v5
    s_lshl4_add_u32 s37, s34, s32
    s_lshl_b32 s38, s37, 7
    s_lshl_b32 s39, s30, 17
    s_add_u32 s39, s39, s38
    s_add_u32 s39, s39, 2097152
    v_lshlrev_b32 v6, 13, v6
    v_lshl_add_u32 v6, v22, 4, v6
    v_add_u32 v152, s39, v6
    v_add_u32 v153, 0x10000, v152
    s_lshl_b32 s39, s30, 16
    s_add_u32 s39, s39, s38
    s_add_u32 s39, s39, 2621440
    v_add_u32 v154, s39, v6
    v_add_u32 v155, 0x40000, v154
    v_add_u32 v156, 0x80000, v154
    v_add_u32 v157, 0xc0000, v154
    v_lshl_add_u32 v16, v22, 2, v21
    s_lshr_b32 s38, s38, 1
    v_lshl_add_u32 v158, v16, 1, s38
    v_lshl_add_u32 v240, v16, 4, v5
    s_lshl_b32 s38, s30, 2
    v_add_u32 v159, s38, v240
    s_bfe_u32 s38, s37, 0x30002
    s_mul_i32 s38, s38, 2
    s_lshr_b32 s39, s37, 5
    s_lshl1_add_u32 s39, s37, s39
    s_and_b32 s36, s39, 1
    s_add_u32 s38, s38, s36
    s_lshl2_add_u32 s38, s38, s30
    s_lshl_b32 s38, s38, 8
    s_add_u32 s100, s38, 4194304
    s_bfe_u32 s38, s37, 0x30002
    s_mul_i32 s38, s38, 2
    s_and_b32 s36, s39, 1
    s_add_u32 s38, s38, s36
    s_lshl2_add_u32 s38, s38, s30
    s_lshl_b32 s38, s38, 9
    s_add_u32 s101, s38, 4325376
    v_lshl_add_u32 v16, v3, 2, v21
    s_mul_i32 s38, s30, 544
    s_add_u32 s38, s38, 400
    v_lshl_add_u32 v16, v16, 1, s38
    v_add_u32 v147, v16, v5
    v_mov_b32 v120, 0x3f803f80
    v_mov_b32 v121, 0x3f803f80
    v_mov_b32 v122, 0x3f803f80
    v_mov_b32 v123, 0x3f803f80
    v_and_b32 v108, 0xff, v4
    v_and_b32 v109, 0xff, v4
    v_and_b32 v110, 0xff, v4
    v_and_b32 v111, 0xff, v4
    s_mov_b32 s40, 200000
Llw_5:
    ds_read_b32 v16, v138 offset:15600
    s_waitcnt lgkmcnt(0)
    v_cmp_eq_u32 vcc, 0, v16
    s_cbranch_vccz Llwd_6
    s_sub_u32 s40, s40, 1
    s_cbranch_scc0 Llw_5
Llwd_6:
    s_mov_b32 s40, 200
L_qs:
    s_load_dwordx2 s[48:49], s[96:97], s56 glc
    s_load_dwordx2 s[50:51], s[96:97], s56 offset:128 glc
    s_waitcnt lgkmcnt(0)
    s_xor_b64 s[36:37], s[48:49], s[58:59]
    s_xor_b64 s[94:95], s[50:51], s[58:59]
    s_lshl_b64 s[94:95], s[94:95], 16
    s_or_b64 s[36:37], s[36:37], s[94:95]
    s_cbranch_scc0 L_qsd
    s_sub_u32 s40, s40, 1
    s_cbranch_scc0 L_qs
L_qsd:
    global_load_dwordx4 v[96:99], v137, s[96:97] offset:0 sc0
    global_load_dwordx4 v[100:103], v137, s[96:97] offset:1024 sc0
    global_load_dwordx4 v[104:107], v137, s[96:97] offset:2048 sc0
    s_mov_b32 exec_hi, 0
    global_load_dwordx4 v[108:111], v137, s[96:97] offset:3072 sc0
    s_mov_b32 exec_hi, -1
    ds_read_b32 v23, v138 offset:15472
    s_waitcnt lgkmcnt(0)
    v_readfirstlane_b32 s35, v23
    s_cmp_eq_u32 s35, 0
    s_cbranch_scc1 L_nok1
    ds_read_b128 v[32:35], v140 offset:0
    ds_read_b128 v[36:39], v141 offset:0
    ds_read_b128 v[40:43], v142 offset:0
    ds_read_b128 v[44:47], v143 offset:0
    ds_read_b128 v[48:51], v140 offset:4096
    ds_read_b128 v[52:55], v141 offset:4096
    ds_read_b128 v[56:59], v142 offset:4096
    ds_read_b128 v[60:63], v143 offset:4096
    ds_read_b128 v[64:67], v140 offset:8192
    ds_read_b128 v[68:71], v141 offset:8192
    ds_read_b128 v[72:75], v142 offset:8192
    ds_read_b128 v[76:79], v143 offset:8192
    ds_read_b128 v[80:83], v140 offset:12288
    ds_read_b128 v[84:87], v141 offset:12288
    ds_read_b128 v[88:91], v142 offset:12288
    ds_read_b128 v[92:95], v143 offset:12288
L_nok1:
    s_mov_b32 s40, 20000
Lpw_7:
    s_waitcnt vmcnt(3)
    v_bitop3_b32 v16, v96, v97, v4 bitop3:0x7e
    v_bitop3_b32 v17, v98, v99, v4 bitop3:0x7e
    v_bitop3_b32 v20, v16, v17, s44 bitop3:0xa8
    v_cmp_ne_u32 s[6:7], 0, v20
    s_waitcnt vmcnt(2)
    v_bitop3_b32 v18, v100, v101, v4 bitop3:0x7e
    v_bitop3_b32 v19, v102, v103, v4 bitop3:0x7e
    v_bitop3_b32 v21, v18, v19, s44 bitop3:0xa8
    v_cmp_ne_u32 s[8:9], 0, v21
    s_waitcnt vmcnt(1)
    v_bitop3_b32 v16, v104, v105, v4 bitop3:0x7e
    v_bitop3_b32 v17, v106, v107, v4 bitop3:0x7e
    v_bitop3_b32 v20, v16, v17, s44 bitop3:0xa8
    v_cmp_ne_u32 s[10:11], 0, v20
    s_waitcnt vmcnt(0)
    v_bitop3_b32 v18, v108, v109, v4 bitop3:0x7e
    v_bitop3_b32 v19, v110, v111, v4 bitop3:0x7e
    v_bitop3_b32 v21, v18, v19, s44 bitop3:0xa8
    v_cmp_ne_u32 s[12:13], 0, v21
    s_or_b64 s[36:37], s[6:7], s[8:9]
    s_or_b64 s[36:37], s[36:37], s[10:11]
    s_or_b64 s[36:37], s[36:37], s[12:13]
    s_cbranch_scc0 Lpwd_8
    s_mov_b64 exec, s[6:7]
    s_cbranch_execz Lpws_9
    global_load_dwordx4 v[96:99], v137, s[96:97] offset:0 sc1
Lpws_9:
    s_mov_b64 exec, s[8:9]
    s_cbranch_execz Lpws_10
    global_load_dwordx4 v[100:103], v137, s[96:97] offset:1024 sc1
Lpws_10:
    s_mov_b64 exec, s[10:11]
    s_cbranch_execz Lpws_11
    global_load_dwordx4 v[104:107], v137, s[96:97] offset:2048 sc1
Lpws_11:
    s_mov_b64 exec, s[12:13]
    s_cbranch_execz Lpws_12
    global_load_dwordx4 v[108:111], v137, s[96:97] offset:3072 sc1
Lpws_12:
    s_mov_b64 exec, -1
    s_waitcnt vmcnt(0)
    s_sub_u32 s40, s40, 1
    s_cbranch_scc0 Lpw_7
Lpwd_8:
    v_and_b32 v96, 0xffffff00, v96
    v_and_b32 v97, 0xffffff00, v97
    v_and_b32 v98, 0xffffff00, v98
    v_and_b32 v99, 0xffffff00, v99
    v_and_b32 v100, 0xffffff00, v100
    v_and_b32 v101, 0xffffff00, v101
    v_and_b32 v102, 0xffffff00, v102
    v_and_b32 v103, 0xffffff00, v103
    v_and_b32 v104, 0xffffff00, v104
    v_and_b32 v105, 0xffffff00, v105
    v_and_b32 v106, 0xffffff00, v106
    v_and_b32 v107, 0xffffff00, v107
    v_and_b32 v108, 0xffffff00, v108
    v_and_b32 v109, 0xffffff00, v109
    v_and_b32 v110, 0xffffff00, v110
    v_and_b32 v111, 0xffffff00, v111
    v_pk_add_f32 v[104:105], v[104:105], v[108:109]
    v_pk_add_f32 v[106:107], v[106:107], v[110:111]
    v_pk_add_f32 v[96:97], v[96:97], v[100:101]
    v_pk_add_f32 v[98:99], v[98:99], v[102:103]
    s_mov_b32 exec_lo, 0
    s_mov_b32 exec_hi, 0xffff0000
    v_pk_add_f32 v[104:105], v[104:105], v[96:97]
    v_pk_add_f32 v[106:107], v[106:107], v[98:99]
    s_mov_b32 exec_lo, -1
    s_mov_b32 exec_hi, 0xffff
    v_cvt_pk_bf16_f32 v96, v96, v97
    v_cvt_pk_bf16_f32 v97, v98, v99
    ds_write_b64 v24, v[96:97] offset:12288
    s_mov_b64 exec, -1
    v_permlane32_swap_b32 v104, v105
    v_permlane32_swap_b32 v106, v107
    v_add_f32 v104, v104, v105
    v_add_f32 v106, v106, v107
    s_nop 1
    v_permlane16_swap_b32 v104, v106
    v_add_f32 v104, v104, v106
    v_mov_b32 v7, 1
    v_cvt_pk_bf16_f32 v104, v104, v104
    ds_write_b16 v147, v104 offset:12288
    ds_write_b32 v138, v7 offset:15456
    s_cmp_lg_u32 s35, 0
    s_cbranch_scc1 L_nok2
    s_mov_b32 s40, 200000
Llw_13:
    ds_read_b32 v16, v138 offset:15472
    s_waitcnt lgkmcnt(0)
    v_cmp_eq_u32 vcc, 0, v16
    s_cbranch_vccz Llwd_14
    s_sub_u32 s40, s40, 1
    s_cbranch_scc0 Llw_13
Llwd_14:
    ds_read_b128 v[32:35], v140 offset:0
    ds_read_b128 v[36:39], v141 offset:0
    ds_read_b128 v[40:43], v142 offset:0
    ds_read_b128 v[44:47], v143 offset:0
    ds_read_b128 v[48:51], v140 offset:4096
    ds_read_b128 v[52:55], v141 offset:4096
    ds_read_b128 v[56:59], v142 offset:4096
    ds_read_b128 v[60:63], v143 offset:4096
    ds_read_b128 v[64:67], v140 offset:8192
    ds_read_b128 v[68:71], v141 offset:8192
    ds_read_b128 v[72:75], v142 offset:8192
    ds_read_b128 v[76:79], v143 offset:8192
    ds_read_b128 v[80:83], v140 offset:12288
    ds_read_b128 v[84:87], v141 offset:12288
    ds_read_b128 v[88:91], v142 offset:12288
    ds_read_b128 v[92:95], v143 offset:12288
L_nok2:
    s_mov_b32 s38, 0x3db504f3
    s_mov_b32 s39, 0x3fb8aa3b
    s_mov_b32 s40, 200000
Llw_15:
    ds_read_b128 v[16:19], v5 offset:15456
    ds_read_b128 v[160:163], v25 offset:12288
    ds_read_b128 v[164:167], v25 offset:12352
    ds_read_b128 v[168:171], v25 offset:12416
    ds_read_b128 v[172:175], v25 offset:12480
    ds_read_b128 v[20:23], v5 offset:15488
    s_waitcnt lgkmcnt(5)
    v_bitop3_b32 v16, v16, v17, v18 bitop3:0x80
    v_and_b32 v16, v16, v19
    v_cmp_eq_u32 vcc, 0, v16
    s_cbranch_vccz Llwd_16
    s_sub_u32 s40, s40, 1
    s_cbranch_scc0 Llw_15
Llwd_16:
    s_waitcnt lgkmcnt(4)
    v_mfma_f32_16x16x32_bf16 v[96:99], v[32:35], v[160:163], 0
    v_mfma_f32_16x16x32_bf16 v[104:107], v[64:67], v[160:163], 0
    s_waitcnt lgkmcnt(0)
    v_bitop3_b32 v20, v20, v21, v22 bitop3:0x80
    v_and_b32 v20, v20, v23
    s_nop 0
    v_readfirstlane_b32 s35, v20
    s_cmp_eq_u32 s35, 0
    s_cbranch_scc1 L_nov1
    ds_read_b64_tr_b16 v[176:177], v144 offset:0
    ds_read_b64_tr_b16 v[178:179], v144 offset:4096
    ds_read_b64_tr_b16 v[180:181], v145 offset:0
    v_mfma_f32_16x16x32_bf16 v[96:99], v[36:39], v[164:167], v[96:99]
    ds_read_b64_tr_b16 v[182:183], v145 offset:4096
    ds_read_b64_tr_b16 v[200:201], v144 offset:24576
    ds_read_b64_tr_b16 v[202:203], v144 offset:28672
    v_mfma_f32_16x16x32_bf16 v[104:107], v[68:71], v[164:167], v[104:107]
    ds_read_b64_tr_b16 v[204:205], v145 offset:24576
    ds_read_b64_tr_b16 v[206:207], v145 offset:28672
    ds_read_b64_tr_b16 v[208:209], v144 offset:32768
    v_mfma_f32_16x16x32_bf16 v[96:99], v[40:43], v[168:171], v[96:99]
    ds_read_b64_tr_b16 v[210:211], v144 offset:36864
    ds_read_b64_tr_b16 v[212:213], v145 offset:32768
    ds_read_b64_tr_b16 v[214:215], v145 offset:36864
    v_mfma_f32_16x16x32_bf16 v[104:107], v[72:75], v[168:171], v[104:107]
    ds_read_b64_tr_b16 v[232:233], v144 offset:57344
    ds_read_b64_tr_b16 v[234:235], v144 offset:61440
    ds_read_b64_tr_b16 v[236:237], v145 offset:57344
    v_mfma_f32_16x16x32_bf16 v[96:99], v[44:47], v[172:175], v[96:99]
    ds_read_b64_tr_b16 v[238:239], v145 offset:61440
    v_mfma_f32_16x16x32_bf16 v[104:107], v[76:79], v[172:175], v[104:107]
    s_branch L_v1d
L_nov1:
    v_mfma_f32_16x16x32_bf16 v[96:99], v[36:39], v[164:167], v[96:99]
    v_mfma_f32_16x16x32_bf16 v[104:107], v[68:71], v[164:167], v[104:107]
    v_mfma_f32_16x16x32_bf16 v[96:99], v[40:43], v[168:171], v[96:99]
    v_mfma_f32_16x16x32_bf16 v[104:107], v[72:75], v[168:171], v[104:107]
    v_mfma_f32_16x16x32_bf16 v[96:99], v[44:47], v[172:175], v[96:99]
    v_mfma_f32_16x16x32_bf16 v[104:107], v[76:79], v[172:175], v[104:107]
L_v1d:
    v_mfma_f32_16x16x32_bf16 v[100:103], v[48:51], v[160:163], 0
    v_mfma_f32_16x16x32_bf16 v[108:111], v[80:83], v[160:163], 0
    v_mfma_f32_16x16x32_bf16 v[100:103], v[52:55], v[164:167], v[100:103]
    v_mfma_f32_16x16x32_bf16 v[108:111], v[84:87], v[164:167], v[108:111]
    s_nop 2
    v_cvt_pk_bf16_f32 v112, v96, v97
    v_cvt_pk_bf16_f32 v113, v98, v99
    s_not_b64 exec, s[46:47]
    v_cvt_pk_bf16_f32 v112, v104, v105
    v_cvt_pk_bf16_f32 v113, v106, v107
    s_mov_b64 exec, -1
    v_mfma_f32_16x16x32_bf16 v[100:103], v[56:59], v[168:171], v[100:103]
    v_lshlrev_b32 v96, 16, v112
    v_and_b32 v97, 0xffff0000, v112
    v_lshlrev_b32 v98, 16, v113
    v_and_b32 v99, 0xffff0000, v113
    v_mfma_f32_16x16x32_bf16 v[108:111], v[88:91], v[168:171], v[108:111]
    v_mul_f32 v96, s38, v96
    v_mul_f32 v97, s38, v97
    v_mul_f32 v98, s38, v98
    v_mul_f32 v99, s38, v99
    v_mfma_f32_16x16x32_bf16 v[100:103], v[60:63], v[172:175], v[100:103]
    v_cvt_pk_bf16_f32 v112, v96, v97
    v_cvt_pk_bf16_f32 v113, v98, v99
    v_mfma_f32_16x16x32_bf16 v[108:111], v[92:95], v[172:175], v[108:111]
    v_lshlrev_b32 v96, 16, v112
    v_and_b32 v97, 0xffff0000, v112
    v_lshlrev_b32 v98, 16, v113
    v_and_b32 v99, 0xffff0000, v113
    v_max3_f32 v116, v96, v97, v98
    v_cvt_pk_bf16_f32 v114, v100, v101
    v_cvt_pk_bf16_f32 v115, v102, v103
    s_not_b64 exec, s[46:47]
    v_cvt_pk_bf16_f32 v114, v108, v109
    v_cvt_pk_bf16_f32 v115, v110, v111
    s_mov_b64 exec, -1
    v_lshlrev_b32 v100, 16, v114
    v_and_b32 v101, 0xffff0000, v114
    v_lshlrev_b32 v102, 16, v115
    v_and_b32 v103, 0xffff0000, v115
    v_mul_f32 v100, s38, v100
    v_mul_f32 v101, s38, v101
    v_mul_f32 v102, s38, v102
    v_mul_f32 v103, s38, v103
    v_cvt_pk_bf16_f32 v114, v100, v101
    v_cvt_pk_bf16_f32 v115, v102, v103
    v_lshlrev_b32 v100, 16, v114
    v_and_b32 v101, 0xffff0000, v114
    v_lshlrev_b32 v102, 16, v115
    v_and_b32 v103, 0xffff0000, v115
    v_max3_f32 v6, v99, v100, v101
    v_max3_f32 v116, v116, v102, v103
    v_max_f32 v116, v116, v6
    s_nop 1
    v_max_f32_dpp v116, v116, v116 row_ror:8 row_mask:0xf bank_mask:0xf
    v_mov_b32 v6, v116
    s_nop 1
    v_permlane16_swap_b32 v6, v116
    v_max_f32 v116, v116, v6
    v_mov_b32 v6, v116
    s_nop 1
    v_permlane32_swap_b32 v6, v116
    v_max_f32 v116, v116, v6
    v_mul_f32 v6, s39, v116
    v_fma_f32 v96, v96, s39, -v6
    v_fma_f32 v97, v97, s39, -v6
    v_fma_f32 v98, v98, s39, -v6
    v_fma_f32 v99, v99, s39, -v6
    v_fma_f32 v100, v100, s39, -v6
    v_fma_f32 v101, v101, s39, -v6
    v_fma_f32 v102, v102, s39, -v6
    v_fma_f32 v103, v103, s39, -v6
    v_exp_f32 v96, v96
    v_exp_f32 v97, v97
    v_exp_f32 v98, v98
    v_exp_f32 v99, v99
    v_exp_f32 v100, v100
    v_exp_f32 v101, v101
    v_exp_f32 v102, v102
    v_exp_f32 v103, v103
    v_cvt_pk_bf16_f32 v112, v96, v97
    v_cvt_pk_bf16_f32 v113, v98, v99
    v_cvt_pk_bf16_f32 v114, v100, v101
    v_cvt_pk_bf16_f32 v115, v102, v103
    s_nop 1
    v_mfma_f32_16x16x32_bf16 v[124:127], v[120:123], v[112:115], 0
    ds_write_b128 v26, v[112:115] offset:0
    v_not_b32 v160, v4
    v_mov_b32 v161, v160
    v_mov_b32 v162, v160
    v_mov_b32 v163, v160
    v_mov_b32 v164, v160
    v_mov_b32 v165, v160
    v_mov_b32 v166, v160
    v_add_f32_dpp v117, v124, v124 row_ror:8 row_mask:0xf bank_mask:0xf
    ds_write_b64 v28, v[116:117] offset:14464
    ds_write_b32 v138, v7 offset:15536
    s_cmp_lg_u32 s35, 0
    s_cbranch_scc1 L_v1e
    s_mov_b32 s40, 200000
Llw_17:
    ds_read_b128 v[16:19], v5 offset:15488
    s_waitcnt lgkmcnt(0)
    v_bitop3_b32 v16, v16, v17, v18 bitop3:0x80
    v_and_b32 v16, v16, v19
    v_cmp_eq_u32 vcc, 0, v16
    s_cbranch_vccz Llwd_18
    s_sub_u32 s40, s40, 1
    s_cbranch_scc0 Llw_17
Llwd_18:
    ds_read_b64_tr_b16 v[176:177], v144 offset:0
    ds_read_b64_tr_b16 v[178:179], v144 offset:4096
    ds_read_b64_tr_b16 v[180:181], v145 offset:0
    ds_read_b64_tr_b16 v[182:183], v145 offset:4096
    ds_read_b64_tr_b16 v[200:201], v144 offset:24576
    ds_read_b64_tr_b16 v[202:203], v144 offset:28672
    ds_read_b64_tr_b16 v[204:205], v145 offset:24576
    ds_read_b64_tr_b16 v[206:207], v145 offset:28672
    ds_read_b64_tr_b16 v[208:209], v144 offset:32768
    ds_read_b64_tr_b16 v[210:211], v144 offset:36864
    ds_read_b64_tr_b16 v[212:213], v145 offset:32768
    ds_read_b64_tr_b16 v[214:215], v145 offset:36864
    ds_read_b64_tr_b16 v[232:233], v144 offset:57344
    ds_read_b64_tr_b16 v[234:235], v144 offset:61440
    ds_read_b64_tr_b16 v[236:237], v145 offset:57344
    ds_read_b64_tr_b16 v[238:239], v145 offset:61440
L_v1e:
    s_mov_b32 s40, 200000
Llw_19:
    ds_read_b128 v[16:19], v5 offset:15536
    ds_read_b128 v[32:35], v27 offset:0
    ds_read_b128 v[44:47], v27 offset:1536
    ds_read_b128 v[48:51], v27 offset:2048
    ds_read_b128 v[60:63], v27 offset:3584
    ds_read_b128 v[20:23], v5 offset:15504
    ds_read_b64 v[128:129], v29 offset:14464
    ds_read_b64 v[130:131], v29 offset:14592
    ds_read_b64 v[132:133], v29 offset:14720
    ds_read_b64 v[134:135], v29 offset:14848
    ds_read_b128 v[36:39], v27 offset:512
    ds_read_b128 v[40:43], v27 offset:1024
    ds_read_b128 v[52:55], v27 offset:2560
    ds_read_b128 v[56:59], v27 offset:3072
    s_waitcnt lgkmcnt(13)
    v_bitop3_b32 v16, v16, v17, v18 bitop3:0x80
    v_and_b32 v16, v16, v19
    v_cmp_eq_u32 vcc, 0, v16
    s_cbranch_vccz Llwd_20
    s_sub_u32 s40, s40, 1
    s_cbranch_scc0 Llw_19
Llwd_20:
    s_waitcnt lgkmcnt(12)
    v_mfma_f32_16x16x32_bf16 v[64:67], v[176:179], v[32:35], 0
    v_mfma_f32_16x16x32_bf16 v[68:71], v[180:183], v[32:35], 0
    s_waitcnt lgkmcnt(0)
    v_bitop3_b32 v20, v20, v21, v22 bitop3:0x80
    v_and_b32 v20, v20, v23
    s_nop 0
    v_readfirstlane_b32 s35, v20
    s_cmp_eq_u32 s35, 0
    s_cbranch_scc1 L_nov2
    ds_read_b64_tr_b16 v[184:185], v144 offset:8192
    ds_read_b64_tr_b16 v[186:187], v144 offset:12288
    ds_read_b64_tr_b16 v[192:193], v144 offset:16384
    v_mfma_f32_16x16x32_bf16 v[72:75], v[200:203], v[44:47], 0
    ds_read_b64_tr_b16 v[194:195], v144 offset:20480
    ds_read_b64_tr_b16 v[216:217], v144 offset:40960
    ds_read_b64_tr_b16 v[218:219], v144 offset:45056
    v_mfma_f32_16x16x32_bf16 v[76:79], v[204:207], v[44:47], 0
    ds_read_b64_tr_b16 v[224:225], v144 offset:49152
    ds_read_b64_tr_b16 v[226:227], v144 offset:53248
    ds_read_b64_tr_b16 v[188:189], v145 offset:8192
    v_mfma_f32_16x16x32_bf16 v[80:83], v[208:211], v[48:51], 0
    ds_read_b64_tr_b16 v[190:191], v145 offset:12288
    ds_read_b64_tr_b16 v[196:197], v145 offset:16384
    ds_read_b64_tr_b16 v[198:199], v145 offset:20480
    v_mfma_f32_16x16x32_bf16 v[84:87], v[212:215], v[48:51], 0
    ds_read_b64_tr_b16 v[220:221], v145 offset:40960
    ds_read_b64_tr_b16 v[222:223], v145 offset:45056
    ds_read_b64_tr_b16 v[228:229], v145 offset:49152
    v_mfma_f32_16x16x32_bf16 v[88:91], v[232:235], v[60:63], 0
    ds_read_b64_tr_b16 v[230:231], v145 offset:53248
    v_mfma_f32_16x16x32_bf16 v[92:95], v[236:239], v[60:63], 0
    s_branch L_v2d
L_nov2:
    v_mfma_f32_16x16x32_bf16 v[72:75], v[200:203], v[44:47], 0
    v_mfma_f32_16x16x32_bf16 v[76:79], v[204:207], v[44:47], 0
    v_mfma_f32_16x16x32_bf16 v[80:83], v[208:211], v[48:51], 0
    v_mfma_f32_16x16x32_bf16 v[84:87], v[212:215], v[48:51], 0
    v_mfma_f32_16x16x32_bf16 v[88:91], v[232:235], v[60:63], 0
    v_mfma_f32_16x16x32_bf16 v[92:95], v[236:239], v[60:63], 0
L_v2d:
    v_max3_f32 v100, v128, v130, v132
    v_max_f32 v100, v100, v134
    v_sub_f32 v128, v128, v100
    v_sub_f32 v130, v130, v100
    v_sub_f32 v132, v132, v100
    v_sub_f32 v134, v134, v100
    v_mul_f32 v128, s39, v128
    v_mul_f32 v130, s39, v130
    v_mul_f32 v132, s39, v132
    v_mul_f32 v134, s39, v134
    v_exp_f32 v128, v128
    v_exp_f32 v130, v130
    v_exp_f32 v132, v132
    v_exp_f32 v134, v134
    s_cmp_lg_u32 s35, 0
    s_cbranch_scc1 L_v2e
    v_mov_b32 v102, v100
    v_mul_f32 v101, v129, v128
    v_fmac_f32 v101, v131, v130
    v_fmac_f32 v101, v133, v132
    v_fmac_f32 v101, v135, v134
    s_lshl_b32 s36, s30, 1
    v_mov_b32 v103, v101
    v_bfi_b32 v100, s44, v4, v100
    v_bfi_b32 v101, s44, v4, v101
    v_bfi_b32 v102, s44, v4, v102
    v_bfi_b32 v103, s44, v4, v103
    s_lshl_b64 exec, 3, s36
    global_store_dwordx4 v31, v[100:103], s[96:97] sc1
    s_mov_b64 exec, -1
    s_mov_b32 s40, 200000
Llw_21:
    ds_read_b128 v[16:19], v5 offset:15504
    s_waitcnt lgkmcnt(0)
    v_bitop3_b32 v16, v16, v17, v18 bitop3:0x80
    v_and_b32 v16, v16, v19
    v_cmp_eq_u32 vcc, 0, v16
    s_cbranch_vccz Llwd_22
    s_sub_u32 s40, s40, 1
    s_cbranch_scc0 Llw_21
Llwd_22:
    ds_read_b64_tr_b16 v[184:185], v144 offset:8192
    ds_read_b64_tr_b16 v[186:187], v144 offset:12288
    ds_read_b64_tr_b16 v[192:193], v144 offset:16384
    ds_read_b64_tr_b16 v[194:195], v144 offset:20480
    ds_read_b64_tr_b16 v[216:217], v144 offset:40960
    ds_read_b64_tr_b16 v[218:219], v144 offset:45056
    ds_read_b64_tr_b16 v[224:225], v144 offset:49152
    ds_read_b64_tr_b16 v[226:227], v144 offset:53248
    ds_read_b64_tr_b16 v[188:189], v145 offset:8192
    ds_read_b64_tr_b16 v[190:191], v145 offset:12288
    ds_read_b64_tr_b16 v[196:197], v145 offset:16384
    ds_read_b64_tr_b16 v[198:199], v145 offset:20480
    ds_read_b64_tr_b16 v[220:221], v145 offset:40960
    ds_read_b64_tr_b16 v[222:223], v145 offset:45056
    ds_read_b64_tr_b16 v[228:229], v145 offset:49152
    ds_read_b64_tr_b16 v[230:231], v145 offset:53248
    s_waitcnt lgkmcnt(14)
    v_mfma_f32_16x16x32_bf16 v[64:67], v[184:187], v[36:39], v[64:67]
    s_waitcnt lgkmcnt(12)
    v_mfma_f32_16x16x32_bf16 v[72:75], v[192:195], v[40:43], v[72:75]
    s_waitcnt lgkmcnt(10)
    v_mfma_f32_16x16x32_bf16 v[80:83], v[216:219], v[52:55], v[80:83]
    s_waitcnt lgkmcnt(8)
    v_mfma_f32_16x16x32_bf16 v[88:91], v[224:227], v[56:59], v[88:91]
    s_waitcnt lgkmcnt(6)
    v_mfma_f32_16x16x32_bf16 v[68:71], v[188:191], v[36:39], v[68:71]
    s_waitcnt lgkmcnt(4)
    v_mfma_f32_16x16x32_bf16 v[76:79], v[196:199], v[40:43], v[76:79]
    s_waitcnt lgkmcnt(2)
    v_mfma_f32_16x16x32_bf16 v[84:87], v[220:223], v[52:55], v[84:87]
    s_waitcnt lgkmcnt(0)
    v_mfma_f32_16x16x32_bf16 v[92:95], v[228:231], v[56:59], v[92:95]
    v_pk_mul_f32 v[96:97], v[64:65], v[128:129] op_sel_hi:[1,0]
    v_pk_mul_f32 v[98:99], v[66:67], v[128:129] op_sel_hi:[1,0]
    v_pk_fma_f32 v[96:97], v[72:73], v[130:131], v[96:97] op_sel_hi:[1,0,1]
    v_pk_fma_f32 v[98:99], v[74:75], v[130:131], v[98:99] op_sel_hi:[1,0,1]
    v_pk_fma_f32 v[96:97], v[80:81], v[132:133], v[96:97] op_sel_hi:[1,0,1]
    v_pk_fma_f32 v[98:99], v[82:83], v[132:133], v[98:99] op_sel_hi:[1,0,1]
    v_pk_fma_f32 v[96:97], v[88:89], v[134:135], v[96:97] op_sel_hi:[1,0,1]
    v_pk_fma_f32 v[98:99], v[90:91], v[134:135], v[98:99] op_sel_hi:[1,0,1]
    s_branch L_pvd
L_v2e:
    s_waitcnt lgkmcnt(0)
    v_mfma_f32_16x16x32_bf16 v[64:67], v[184:187], v[36:39], v[64:67]
    v_mov_b32 v102, v100
    v_mul_f32 v101, v129, v128
    v_fmac_f32 v101, v131, v130
    v_mfma_f32_16x16x32_bf16 v[72:75], v[192:195], v[40:43], v[72:75]
    v_fmac_f32 v101, v133, v132
    v_fmac_f32 v101, v135, v134
    s_lshl_b32 s36, s30, 1
    v_mfma_f32_16x16x32_bf16 v[80:83], v[216:219], v[52:55], v[80:83]
    v_mov_b32 v103, v101
    v_bfi_b32 v100, s44, v4, v100
    v_bfi_b32 v101, s44, v4, v101
    v_mfma_f32_16x16x32_bf16 v[88:91], v[224:227], v[56:59], v[88:91]
    v_bfi_b32 v102, s44, v4, v102
    v_bfi_b32 v103, s44, v4, v103
    v_mfma_f32_16x16x32_bf16 v[68:71], v[188:191], v[36:39], v[68:71]
    v_pk_mul_f32 v[96:97], v[64:65], v[128:129] op_sel_hi:[1,0]
    v_pk_mul_f32 v[98:99], v[66:67], v[128:129] op_sel_hi:[1,0]
    v_mfma_f32_16x16x32_bf16 v[76:79], v[196:199], v[40:43], v[76:79]
    v_pk_fma_f32 v[96:97], v[72:73], v[130:131], v[96:97] op_sel_hi:[1,0,1]
    v_pk_fma_f32 v[98:99], v[74:75], v[130:131], v[98:99] op_sel_hi:[1,0,1]
    v_mfma_f32_16x16x32_bf16 v[84:87], v[220:223], v[52:55], v[84:87]
    v_pk_fma_f32 v[96:97], v[80:81], v[132:133], v[96:97] op_sel_hi:[1,0,1]
    v_pk_fma_f32 v[98:99], v[82:83], v[132:133], v[98:99] op_sel_hi:[1,0,1]
    v_mfma_f32_16x16x32_bf16 v[92:95], v[228:231], v[56:59], v[92:95]
    v_pk_fma_f32 v[96:97], v[88:89], v[134:135], v[96:97] op_sel_hi:[1,0,1]
    v_pk_fma_f32 v[98:99], v[90:91], v[134:135], v[98:99] op_sel_hi:[1,0,1]
    s_lshl_b64 exec, 3, s36
    global_store_dwordx4 v31, v[100:103], s[96:97] sc1
    s_mov_b64 exec, -1
L_pvd:
    s_not_b64 exec, s[46:47]
    v_pk_mul_f32 v[96:97], v[68:69], v[128:129] op_sel_hi:[1,0]
    v_pk_mul_f32 v[98:99], v[70:71], v[128:129] op_sel_hi:[1,0]
    v_pk_fma_f32 v[96:97], v[76:77], v[130:131], v[96:97] op_sel_hi:[1,0,1]
    v_pk_fma_f32 v[98:99], v[78:79], v[130:131], v[98:99] op_sel_hi:[1,0,1]
    v_pk_fma_f32 v[96:97], v[84:85], v[132:133], v[96:97] op_sel_hi:[1,0,1]
    v_pk_fma_f32 v[98:99], v[86:87], v[132:133], v[98:99] op_sel_hi:[1,0,1]
    v_pk_fma_f32 v[96:97], v[92:93], v[134:135], v[96:97] op_sel_hi:[1,0,1]
    v_pk_fma_f32 v[98:99], v[94:95], v[134:135], v[98:99] op_sel_hi:[1,0,1]
    s_mov_b64 exec, -1
    v_bfi_b32 v96, s44, v4, v96
    v_bfi_b32 v97, s44, v4, v97
    v_bfi_b32 v98, s44, v4, v98
    v_bfi_b32 v99, s44, v4, v99
    global_store_dwordx4 v30, v[96:99], s[96:97] sc1
    s_mov_b64 exec, 0xf
    global_store_byte v146, v4, s[96:97] sc1
    s_mov_b64 exec, -1
    v_mov_b32 v167, v160
    v_mov_b32 v168, v160
    v_mov_b32 v169, v160
    v_mov_b32 v170, v160
    v_mov_b32 v171, v160
    v_mov_b32 v172, v160
    v_mov_b32 v173, v160
    v_mov_b32 v174, v160
    v_mov_b32 v175, v160
    s_mov_b32 s40, 200
    s_mov_b32 s92, 0x7f7f7f7f
    s_mov_b32 s93, 0x7f7f7f7f
    s_not_b64 s[48:49], s[58:59]
    s_not_b64 s[50:51], s[58:59]
Lsp_23:
    s_load_dwordx2 s[48:49], s[96:97], s98 offset:0 glc
    s_load_dwordx2 s[50:51], s[96:97], s98 offset:128 glc
    s_waitcnt lgkmcnt(8)
    s_xor_b64 s[36:37], s[48:49], s[58:59]
    s_xor_b64 s[94:95], s[50:51], s[58:59]
    s_or_b64 s[36:37], s[36:37], s[94:95]
    s_cbranch_scc0 Lspd_24
    s_sub_u32 s40, s40, 1
    s_cbranch_scc0 Lsp_23
Lspd_24:
    global_load_dwordx4 v[168:171], v149, s[96:97] offset:0 sc1
    global_load_dwordx4 v[160:163], v148, s[96:97] offset:0 sc1
    global_load_dwordx4 v[172:175], v149, s[96:97] offset:128 sc1
    global_load_dwordx4 v[164:167], v148, s[96:97] offset:1024 sc1
    s_mov_b64 s[6:7], 0
    s_mov_b64 s[8:9], 0
    s_mov_b32 s40, 20000
Lpvk_27:
    s_mov_b32 s41, 4
Lpv_25:
    v_bitop3_b32 v16, v168, v169, v4 bitop3:0x7e
    v_bitop3_b32 v17, v170, v171, v4 bitop3:0x7e
    v_or_b32 v20, v16, v17
    v_bitop3_b32 v16, v160, v161, v4 bitop3:0x7e
    v_bitop3_b32 v17, v162, v163, v4 bitop3:0x7e
    v_or3_b32 v20, v16, v17, v20
    v_and_b32 v20, 0xff, v20
    v_cmp_ne_u32 s[14:15], 0, v20
    v_bitop3_b32 v18, v172, v173, v4 bitop3:0x7e
    v_bitop3_b32 v19, v174, v175, v4 bitop3:0x7e
    v_or_b32 v21, v18, v19
    v_bitop3_b32 v18, v164, v165, v4 bitop3:0x7e
    v_bitop3_b32 v19, v166, v167, v4 bitop3:0x7e
    v_or3_b32 v21, v18, v19, v21
    v_and_b32 v21, 0xff, v21
    v_cmp_ne_u32 s[16:17], 0, v21
    s_or_b64 s[36:37], s[14:15], s[16:17]
    s_cbranch_scc0 Lpvd_26
    s_sub_u32 s41, s41, 1
    s_cbranch_scc0 Lpv_25
    s_and_b64 exec, s[14:15], s[6:7]
    s_cbranch_execz Lpvs_28
    global_load_dwordx4 v[168:171], v149, s[96:97] offset:0 sc1
    global_load_dwordx4 v[160:163], v148, s[96:97] offset:0 sc1
Lpvs_28:
    s_and_b64 exec, s[16:17], s[8:9]
    s_cbranch_execz Lpvs_29
    global_load_dwordx4 v[172:175], v149, s[96:97] offset:128 sc1
    global_load_dwordx4 v[164:167], v148, s[96:97] offset:1024 sc1
Lpvs_29:
    s_mov_b64 exec, -1
    s_waitcnt vmcnt(40)
    s_cmp_lg_u32 s40, 19997
    s_cbranch_scc1 Lpvn_30
    s_mov_b64 s[6:7], -1
    s_mov_b64 s[8:9], -1
Lpvn_30:
    s_sub_u32 s40, s40, 1
    s_cbranch_scc0 Lpvk_27
Lpvd_26:
    v_and_b32 v40, 0xffffff00, v168
    v_and_b32 v44, 0xffffff00, v172
    v_max_f32 v16, v40, v44
    v_and_b32 v41, 0xffffff00, v169
    v_and_b32 v45, 0xffffff00, v173
    v_max_f32_dpp v16, v16, v16 row_ror:8 row_mask:0xf bank_mask:0xf
    v_mov_b32 v17, v16
    v_and_b32 v32, 0xffffff00, v160
    v_and_b32 v33, 0xffffff00, v161
    v_permlane16_swap_b32 v17, v16
    v_max_f32 v16, v16, v17
    v_mov_b32 v17, v16
    v_and_b32 v34, 0xffffff00, v162
    v_and_b32 v35, 0xffffff00, v163
    v_permlane32_swap_b32 v17, v16
    v_max_f32 v16, v16, v17
    v_sub_f32 v40, v40, v16
    v_sub_f32 v44, v44, v16
    v_mul_f32 v40, s39, v40
    v_mul_f32 v44, s39, v44
    v_exp_f32 v40, v40
    v_exp_f32 v44, v44
    v_and_b32 v36, 0xffffff00, v164
    v_and_b32 v37, 0xffffff00, v165
    v_and_b32 v38, 0xffffff00, v166
    v_and_b32 v39, 0xffffff00, v167
    v_mul_f32 v18, v40, v41
    v_fmac_f32 v18, v44, v45
    v_mul_f32 v32, v32, v40
    v_mul_f32 v33, v33, v40
    v_add_f32_dpp v18, v18, v18 row_ror:8 row_mask:0xf bank_mask:0xf
    v_mul_f32 v34, v34, v40
    v_mul_f32 v35, v35, v40
    v_mov_b32 v17, v18
    v_fmac_f32 v32, v36, v44
    v_fmac_f32 v33, v37, v44
    v_permlane16_swap_b32 v17, v18
    v_fmac_f32 v34, v38, v44
    v_fmac_f32 v35, v39, v44
    v_add_f32 v18, v18, v17
    v_permlane32_swap_b32 v32, v33
    v_mov_b32 v17, v18
    v_permlane32_swap_b32 v34, v35
    v_add_f32 v32, v32, v33
    v_add_f32 v34, v34, v35
    v_permlane32_swap_b32 v17, v18
    v_add_f32 v18, v18, v17
    v_permlane16_swap_b32 v32, v34
    v_add_f32 v32, v32, v34
    v_rcp_f32 v18, v18
    s_nop 0
    v_add_f32_dpp v32, v32, v32 row_ror:8 row_mask:0xf bank_mask:0xf
    v_mul_f32 v32, v32, v18
    v_cvt_pk_bf16_f32 v32, v32, v32
    ds_write_b16 v150, v32 offset:14976
    ds_write_b32 v138, v7 offset:15440
    s_bitcmp1_b32 s2, 2
    s_cbranch_scc1 L_fin2
    v_not_b32 v64, v4
    v_mov_b32 v65, v64
    v_mov_b32 v66, v64
    v_mov_b32 v67, v64
    v_mov_b32 v68, v64
    v_mov_b32 v69, v64
    v_mov_b32 v70, v64
    v_mov_b32 v71, v64
    v_mov_b32 v72, v64
    v_mov_b32 v73, v64
    v_mov_b32 v74, v64
    v_mov_b32 v75, v64
    v_mov_b32 v76, v64
    v_mov_b32 v77, v64
    v_mov_b32 v78, v64
    v_mov_b32 v79, v64
    s_movk_i32 s41, 0xf
    s_cmp_lt_u32 s30, 3
    s_cbranch_scc1 L_f6
    s_movk_i32 s41, 0x7
    v_and_b32 v76, 0xff, v4
    v_and_b32 v77, 0xff, v4
    v_and_b32 v78, 0xff, v4
    v_and_b32 v79, 0xff, v4
L_f6:
    s_mov_b32 s40, 200
L_fp:
    s_bitcmp1_b32 s41, 0
    s_cbranch_scc0 L_fl0
    s_load_dwordx2 s[76:77], s[96:97], s100 offset:0 glc
L_fl0:
    s_bitcmp1_b32 s41, 1
    s_cbranch_scc0 L_fl1
    s_load_dwordx2 s[78:79], s[96:97], s100 offset:128 glc
L_fl1:
    s_bitcmp1_b32 s41, 2
    s_cbranch_scc0 L_fl2
    s_load_dwordx2 s[80:81], s[96:97], s101 offset:0 glc
L_fl2:
    s_bitcmp1_b32 s41, 3
    s_cbranch_scc0 L_fl3
    s_load_dwordx2 s[82:83], s[96:97], s101 offset:128 glc
L_fl3:
    s_waitcnt lgkmcnt(0)
    s_mov_b32 s35, 0
    s_bitcmp1_b32 s41, 0
    s_cbranch_scc0 L_fq0
    s_xor_b64 s[36:37], s[76:77], s[58:59]
    s_cbranch_scc1 L_fm0
    global_load_dwordx4 v[64:67], v152, s[96:97] sc1
    s_bitset0_b32 s41, 0
    s_branch L_fq0
L_fm0:
    s_and_b64 s[94:95], s[36:37], s[92:93]
    s_add_u32 s94, s94, s92
    s_add_u32 s95, s95, s92
    s_or_b64 s[94:95], s[94:95], s[36:37]
    s_andn2_b64 s[94:95], s[94:95], s[92:93]
    s_bcnt1_i32_b64 s36, s[94:95]
    s_add_u32 s35, s35, s36
L_fq0:
    s_bitcmp1_b32 s41, 1
    s_cbranch_scc0 L_fq1
    s_xor_b64 s[36:37], s[78:79], s[58:59]
    s_cbranch_scc1 L_fm1
    global_load_dwordx4 v[68:71], v153, s[96:97] sc1
    s_bitset0_b32 s41, 1
    s_branch L_fq1
L_fm1:
    s_and_b64 s[94:95], s[36:37], s[92:93]
    s_add_u32 s94, s94, s92
    s_add_u32 s95, s95, s92
    s_or_b64 s[94:95], s[94:95], s[36:37]
    s_andn2_b64 s[94:95], s[94:95], s[92:93]
    s_bcnt1_i32_b64 s36, s[94:95]
    s_add_u32 s35, s35, s36
L_fq1:
    s_bitcmp1_b32 s41, 2
    s_cbranch_scc0 L_fq2
    s_xor_b64 s[36:37], s[80:81], s[58:59]
    s_cbranch_scc1 L_fm2
    global_load_dwordx4 v[72:75], v154, s[96:97] sc1
    s_bitset0_b32 s41, 2
    s_branch L_fq2
L_fm2:
    s_and_b64 s[94:95], s[36:37], s[92:93]
    s_add_u32 s94, s94, s92
    s_add_u32 s95, s95, s92
    s_or_b64 s[94:95], s[94:95], s[36:37]
    s_andn2_b64 s[94:95], s[94:95], s[92:93]
    s_bcnt1_i32_b64 s36, s[94:95]
    s_add_u32 s35, s35, s36
L_fq2:
    s_bitcmp1_b32 s41, 3
    s_cbranch_scc0 L_fq3
    s_xor_b64 s[36:37], s[82:83], s[58:59]
    s_cbranch_scc1 L_fm3
    global_load_dwordx4 v[76:79], v155, s[96:97] sc1
    s_bitset0_b32 s41, 3
    s_branch L_fq3
L_fm3:
    s_and_b64 s[94:95], s[36:37], s[92:93]
    s_add_u32 s94, s94, s92
    s_add_u32 s95, s95, s92
    s_or_b64 s[94:95], s[94:95], s[36:37]
    s_andn2_b64 s[94:95], s[94:95], s[92:93]
    s_bcnt1_i32_b64 s36, s[94:95]
    s_add_u32 s35, s35, s36
L_fq3:
    s_cmp_le_u32 s35, 3
    s_cbranch_scc1 L_fpd
    s_sub_u32 s40, s40, 1
    s_cbranch_scc0 L_fp
L_fpd:
    s_bitcmp1_b32 s41, 0
    s_cbranch_scc0 L_ft0
    global_load_dwordx4 v[64:67], v152, s[96:97] sc1
L_ft0:
    s_bitcmp1_b32 s41, 1
    s_cbranch_scc0 L_ft1
    global_load_dwordx4 v[68:71], v153, s[96:97] sc1
L_ft1:
    s_bitcmp1_b32 s41, 2
    s_cbranch_scc0 L_ft2
    global_load_dwordx4 v[72:75], v154, s[96:97] sc1
L_ft2:
    s_bitcmp1_b32 s41, 3
    s_cbranch_scc0 L_ft3
    global_load_dwordx4 v[76:79], v155, s[96:97] sc1
L_ft3:
    s_mov_b32 s40, 100000
    s_waitcnt vmcnt(0)
L_fs:
    v_bitop3_b32 v16, v64, v65, v4 bitop3:0x7e
    v_bitop3_b32 v17, v66, v67, v4 bitop3:0x7e
    v_bitop3_b32 v20, v16, v17, s44 bitop3:0xa8
    v_cmp_ne_u32 s[64:65], 0, v20
    v_bitop3_b32 v18, v68, v69, v4 bitop3:0x7e
    v_bitop3_b32 v19, v70, v71, v4 bitop3:0x7e
    v_bitop3_b32 v21, v18, v19, s44 bitop3:0xa8
    v_cmp_ne_u32 s[66:67], 0, v21
    v_bitop3_b32 v16, v72, v73, v4 bitop3:0x7e
    v_bitop3_b32 v17, v74, v75, v4 bitop3:0x7e
    v_bitop3_b32 v20, v16, v17, s44 bitop3:0xa8
    v_cmp_ne_u32 s[68:69], 0, v20
    v_bitop3_b32 v18, v76, v77, v4 bitop3:0x7e
    v_bitop3_b32 v19, v78, v79, v4 bitop3:0x7e
    v_bitop3_b32 v21, v18, v19, s44 bitop3:0xa8
    v_cmp_ne_u32 s[70:71], 0, v21
    s_or_b64 s[36:37], s[64:65], s[66:67]
    s_or_b64 s[36:37], s[36:37], s[68:69]
    s_or_b64 s[36:37], s[36:37], s[70:71]
    s_cbranch_scc0 L_fsd
    s_mov_b64 exec, s[64:65]
    s_cbranch_execz L_fk0
    global_load_dwordx4 v[64:67], v152, s[96:97] sc1
L_fk0:
    s_mov_b64 exec, s[66:67]
    s_cbranch_execz L_fk1
    global_load_dwordx4 v[68:71], v153, s[96:97] sc1
L_fk1:
    s_mov_b64 exec, s[68:69]
    s_cbranch_execz L_fk2
    global_load_dwordx4 v[72:75], v154, s[96:97] sc1
L_fk2:
    s_mov_b64 exec, s[70:71]
    s_cbranch_execz L_fk3
    global_load_dwordx4 v[76:79], v155, s[96:97] sc1
L_fk3:
    s_mov_b64 exec, -1
    s_bcnt1_i32_b64 s41, s[36:37]
    s_cmp_le_u32 s41, 24
    s_cbranch_scc1 L_ffast
    s_waitcnt vmcnt(0)
L_ffast:
    s_waitcnt vmcnt(32)
    s_sub_u32 s40, s40, 1
    s_cbranch_scc0 L_fs
L_fsd:
    v_and_b32 v96, 0xffffff00, v64
    v_and_b32 v97, 0xffffff00, v65
    v_and_b32 v98, 0xffffff00, v66
    v_and_b32 v99, 0xffffff00, v67
    v_and_b32 v100, 0xffffff00, v68
    v_and_b32 v101, 0xffffff00, v69
    v_and_b32 v102, 0xffffff00, v70
    v_and_b32 v103, 0xffffff00, v71
    v_and_b32 v104, 0xffffff00, v72
    v_and_b32 v105, 0xffffff00, v73
    v_and_b32 v106, 0xffffff00, v74
    v_and_b32 v107, 0xffffff00, v75
    v_and_b32 v108, 0xffffff00, v76
    v_and_b32 v109, 0xffffff00, v77
    v_and_b32 v110, 0xffffff00, v78
    v_and_b32 v111, 0xffffff00, v79
    v_pk_add_f32 v[96:97], v[96:97], v[104:105]
    v_pk_add_f32 v[98:99], v[98:99], v[106:107]
    v_pk_add_f32 v[100:101], v[100:101], v[108:109]
    v_pk_add_f32 v[102:103], v[102:103], v[110:111]
    v_pk_add_f32 v[96:97], v[96:97], v[100:101]
    v_pk_add_f32 v[98:99], v[98:99], v[102:103]
    s_nop 0
    v_permlane32_swap_b32 v96, v97
    v_permlane32_swap_b32 v98, v99
    v_add_f32 v96, v96, v97
    v_add_f32 v98, v98, v99
    s_nop 1
    v_permlane16_swap_b32 v96, v98
    v_add_f32 v96, v96, v98
    s_nop 1
    v_add_f32_dpp v96, v96, v96 row_ror:8 row_mask:0xf bank_mask:0xf
    ds_write_b32 v159, v96 offset:8192
    s_mov_b64 exec, 1
    ds_add_rtn_u32 v16, v5, v7 offset:15424
    s_mov_b64 exec, -1
    ds_read_b128 v[20:23], v240 offset:8192
    s_waitcnt lgkmcnt(1)
    v_readfirstlane_b32 s37, v16
    s_cmp_lg_u32 s37, 3
    s_cbranch_scc1 L_fin3
    s_waitcnt lgkmcnt(0)
    v_pk_add_f32 v[20:21], v[20:21], v[22:23]
    s_mov_b64 exec, s[46:47]
    v_add_f32 v20, v20, v21
    v_cvt_pk_bf16_f32 v16, v20, v20
    global_store_short v158, v16, s[24:25]
    s_cmp_lg_u32 s2, 0
    s_cbranch_scc1 L_noep
    v_mov_b32 v17, 0
    s_mov_b64 exec, 1
    global_store_dword v17, v4, s[96:97] sc1
L_noep:
    s_mov_b64 exec, -1
L_fin3:
    s_branch L_fin2
L_AF:
    s_lshr_b32 s35, s30, 1
    s_lshl1_add_u32 s38, s28, s57
    s_lshl1_add_u32 s38, s38, s35
    s_lshl_b32 s38, s38, 7
    s_add_u32 s38, s38, 327680
    s_xor_b32 s98, s38, 512
    v_and_b32 v6, 31, v1
    v_lshl_add_u32 v26, v6, 2, s38
    s_lshl3_add_u32 s38, s57, s35
    s_lshl_b32 s39, s38, 6
    v_add_u32 v27, s39, v5
    s_lshl_b32 s39, s38, 4
    v_add_u32 v24, s39, v5
    v_bfe_u32 v6, v1, 2, 1
    v_lshl_add_u32 v27, v6, 8, v27
    v_bfe_u32 v6, v1, 3, 2
    v_lshl_add_u32 v27, v6, 4, v27
    v_and_b32 v6, 3, v1
    v_lshl_add_u32 v27, v6, 2, v27
    v_lshl_add_u32 v24, v6, 5, v24
    v_bfe_u32 v6, v1, 2, 3
    v_lshl_add_u32 v24, v6, 1, v24
    v_mov_b32 v29, 0x3d372713
    v_mov_b32 v7, 1
    v_and_b32 v30, 0xff, v4
    s_bitcmp1_b32 s28, 0
    s_cselect_b64 s[94:95], -1, 0
    s_mov_b32 exec_hi, 0
    v_mov_b32 v31, 0
    s_cmp_lg_u32 s29, 2
    s_cbranch_scc1 L_hgo
    s_bitcmp1_b32 s28, 1
    s_cbranch_scc1 L_hS
    v_add_u32 v28, 65536, v26
    s_mov_b32 s40, 200000
Llw_31:
    ds_read_b128 v[16:19], v5 offset:15472
    ds_read_b32 v32, v27 offset:8192
    ds_read_b32 v33, v27 offset:9216
    ds_read_b32 v34, v27 offset:10240
    ds_read_b32 v35, v27 offset:11264
    s_waitcnt lgkmcnt(4)
    v_bitop3_b32 v16, v16, v17, v18 bitop3:0x80
    v_and_b32 v16, v16, v19
    v_cmp_eq_u32 vcc, 0, v16
    s_cbranch_vccz Llwd_32
    s_sub_u32 s40, s40, 1
    s_cbranch_scc0 Llw_31
Llwd_32:
    s_waitcnt lgkmcnt(0)
    v_pk_add_f32 v[32:33], v[32:33], v[34:35]
    v_add_f32 v32, v32, v33
    v_bfi_b32 v32, s44, v4, v32
    global_store_dword v28, v32, s[96:97] sc1
    s_branch L_hgo
L_hS:
    s_xor_b32 s101, s98, 512
    s_add_u32 s101, s101, 64512
    s_mov_b32 s100, 20000
L_hph:
    s_load_dwordx16 s[28:43], s[96:97], s101 offset:0 glc
    s_load_dwordx16 s[44:59], s[96:97], s101 offset:64 glc
    s_waitcnt lgkmcnt(0)
    s_xor_b32 s92, s43, s99
    s_xor_b32 s93, s59, s99
    s_or_b32 s92, s92, s93
    s_and_b32 s92, s92, 0xff
    s_cbranch_scc0 L_hvh
L_hch:
    s_sub_u32 s100, s100, 1
    s_cbranch_scc0 L_hph
    s_branch L_hdh
L_hvh:
    v_writelane_b32 v31, s28, 0
    v_writelane_b32 v31, s29, 1
    v_writelane_b32 v31, s30, 2
    v_writelane_b32 v31, s31, 3
    v_writelane_b32 v31, s32, 4
    v_writelane_b32 v31, s33, 5
    v_writelane_b32 v31, s34, 6
    v_writelane_b32 v31, s35, 7
    v_writelane_b32 v31, s36, 8
    v_writelane_b32 v31, s37, 9
    v_writelane_b32 v31, s38, 10
    v_writelane_b32 v31, s39, 11
    v_writelane_b32 v31, s40, 12
    v_writelane_b32 v31, s41, 13
    v_writelane_b32 v31, s42, 14
    v_writelane_b32 v31, s43, 15
    v_writelane_b32 v31, s44, 16
    v_writelane_b32 v31, s45, 17
    v_writelane_b32 v31, s46, 18
    v_writelane_b32 v31, s47, 19
    v_writelane_b32 v31, s48, 20
    v_writelane_b32 v31, s49, 21
    v_writelane_b32 v31, s50, 22
    v_writelane_b32 v31, s51, 23
    v_writelane_b32 v31, s52, 24
    v_writelane_b32 v31, s53, 25
    v_writelane_b32 v31, s54, 26
    v_writelane_b32 v31, s55, 27
    v_writelane_b32 v31, s56, 28
    v_writelane_b32 v31, s57, 29
    v_writelane_b32 v31, s58, 30
    v_writelane_b32 v31, s59, 31
    v_xor_b32 v16, v31, v4
    v_and_b32 v16, 0xff, v16
    v_cmp_ne_u32 vcc, 0, v16
    s_cbranch_vccnz L_hch
L_hdh:
    v_and_b32 v31, 0xffffff00, v31
L_hgo:
    s_mov_b32 s40, 200000
Llw_33:
    ds_read_b128 v[16:19], v5 offset:15520
    ds_read_b32 v32, v27 offset:4096
    ds_read_b32 v33, v27 offset:5120
    ds_read_b32 v34, v27 offset:6144
    ds_read_b32 v35, v27 offset:7168
    s_waitcnt lgkmcnt(4)
    v_bitop3_b32 v16, v16, v17, v18 bitop3:0x80
    v_and_b32 v16, v16, v19
    v_cmp_eq_u32 vcc, 0, v16
    s_cbranch_vccz Llwd_34
    s_sub_u32 s40, s40, 1
    s_cbranch_scc0 Llw_33
Llwd_34:
    s_waitcnt lgkmcnt(0)
    v_pk_add_f32 v[32:33], v[32:33], v[34:35]
    v_add_f32 v32, v32, v33
    v_add_f32 v32, v32, v31
    v_cvt_pk_bf16_f32 v32, v32, v32
    v_lshl_or_b32 v32, v32, 16, v30
    global_store_dword v26, v32, s[96:97] sc1
    s_mov_b32 s100, 20000
L_hp:
    s_load_dwordx16 s[28:43], s[96:97], s98 offset:0 glc
    s_load_dwordx16 s[44:59], s[96:97], s98 offset:64 glc
    s_waitcnt lgkmcnt(0)
    s_xor_b32 s92, s43, s99
    s_xor_b32 s93, s59, s99
    s_or_b32 s92, s92, s93
    s_and_b32 s92, s92, 0xff
    s_cbranch_scc0 L_hv
L_hc:
    s_sub_u32 s100, s100, 1
    s_cbranch_scc0 L_hp
    s_branch L_hd
L_hv:
    v_writelane_b32 v48, s28, 0
    v_writelane_b32 v48, s29, 1
    v_writelane_b32 v48, s30, 2
    v_writelane_b32 v48, s31, 3
    v_writelane_b32 v48, s32, 4
    v_writelane_b32 v48, s33, 5
    v_writelane_b32 v48, s34, 6
    v_writelane_b32 v48, s35, 7
    v_writelane_b32 v48, s36, 8
    v_writelane_b32 v48, s37, 9
    v_writelane_b32 v48, s38, 10
    v_writelane_b32 v48, s39, 11
    v_writelane_b32 v48, s40, 12
    v_writelane_b32 v48, s41, 13
    v_writelane_b32 v48, s42, 14
    v_writelane_b32 v48, s43, 15
    v_writelane_b32 v48, s44, 16
    v_writelane_b32 v48, s45, 17
    v_writelane_b32 v48, s46, 18
    v_writelane_b32 v48, s47, 19
    v_writelane_b32 v48, s48, 20
    v_writelane_b32 v48, s49, 21
    v_writelane_b32 v48, s50, 22
    v_writelane_b32 v48, s51, 23
    v_writelane_b32 v48, s52, 24
    v_writelane_b32 v48, s53, 25
    v_writelane_b32 v48, s54, 26
    v_writelane_b32 v48, s55, 27
    v_writelane_b32 v48, s56, 28
    v_writelane_b32 v48, s57, 29
    v_writelane_b32 v48, s58, 30
    v_writelane_b32 v48, s59, 31
    v_xor_b32 v16, v48, v4
    v_and_b32 v16, 0xff, v16
    v_cmp_ne_u32 vcc, 0, v16
    s_cbranch_vccnz L_hc
L_hd:
    v_cndmask_b32_e64 v34, v32, v48, s[94:95]
    v_cndmask_b32_e64 v35, v48, v32, s[94:95]
    v_cvt_pk_bf16_f32 v35, v34, v35
    v_lshlrev_b32 v34, 16, v35
    v_and_b32 v35, 0xffff0000, v35
    v_mul_f32 v16, v34, v34
    v_mul_f32 v17, 0xc0135761, v34
    v_fma_f32 v16, v16, v29, 1.0
    v_mul_f32 v16, v16, v17
    v_exp_f32 v16, v16
    s_nop 0
    v_add_f32 v16, 1.0, v16
    v_rcp_f32 v16, v16
    s_nop 0
    v_mul_f32 v16, v16, v34
    v_cvt_pk_bf16_f32 v16, v16, v16
    v_and_b32 v16, 0xffff0000, v16
    v_mul_f32 v16, v16, v35
    v_cvt_pk_bf16_f32 v16, v16, v16
    ds_write_b16 v24, v16 offset:14976
    ds_write_b32 v138, v7 offset:15584
    s_mov_b64 exec, -1
    s_branch L_fin
L_BA:
    v_xor_b32 v244, 0x22000, v240
    v_xor_b32 v245, 0x22080, v240
    v_xor_b32 v246, 0x33000, v240
    v_xor_b32 v247, 0x33080, v240
    s_movk_i32 s44, 0xff
    s_mov_b32 s46, 0x00ff00ff
    s_mov_b32 s47, 0x00ff00ff
    v_lshlrev_b32 v6, 4, v1
    v_mov_b32 v16, 0x0d0c
    v_mov_b32 v17, 0
    v_lshlrev_b64 v[18:19], v6, v[16:17]
    v_mov_b32 v16, 0x0f0e
    v_lshlrev_b64 v[20:21], v6, v[16:17]
    v_bfe_i32 v7, v1, 2, 1
    v_mov_b32 v22, 0x0c0c0c0c
    v_bitop3_b32 v8, v18, v7, v22 bitop3:0x9a
    v_bitop3_b32 v9, v19, v7, v22 bitop3:0x9a
    v_bitop3_b32 v10, v18, v7, v22 bitop3:0x6a
    v_bitop3_b32 v11, v19, v7, v22 bitop3:0x6a
    v_bitop3_b32 v12, v20, v7, v22 bitop3:0x9a
    v_bitop3_b32 v13, v21, v7, v22 bitop3:0x9a
    v_bitop3_b32 v14, v20, v7, v22 bitop3:0x6a
    v_bitop3_b32 v15, v21, v7, v22 bitop3:0x6a
    s_sub_u32 s30, s30, 4
    s_lshl_b32 s38, s30, 2
    v_add_u32 v250, s38, v5
    v_lshlrev_b32 v22, 11, v2
    v_lshl_add_u32 v22, v3, 4, v22
    v_lshrrev_b32 v23, 3, v3
    v_and_b32 v6, 1, v2
    v_lshlrev_b32 v6, 4, v6
    v_lshl_add_u32 v6, v3, 5, v6
    v_lshrrev_b32 v16, 1, v2
    v_lshl_add_u32 v21, v16, 12, v6
    v_lshl_add_u32 v252, v16, 3, v5
    s_bfe_u32 s28, s2, 0x10002
    s_lshl4_add_u32 s28, s28, s32
    v_mov_b32 v7, 1
    s_waitcnt lgkmcnt(0)
    s_add_u32 s99, s99, 1
    v_mov_b32 v4, s99
    s_and_b32 s58, s99, 0xff
    s_mul_i32 s58, s58, 0x01010101
    s_mov_b32 s59, s58
    s_lshr_b32 s37, s28, 1
    s_lshl4_add_u32 s37, s34, s37
    s_and_b32 s36, s28, 1
    s_lshl2_add_u32 s36, s36, s30
    s_lshl_b32 s38, s37, 9
    s_add_u32 s38, s38, s36
    s_lshl_b32 s38, s38, 8
    v_add_u32 v248, s38, v22
    s_lshl4_add_u32 s38, s37, s36
    s_lshl_b32 s38, s38, 9
    s_add_u32 s38, s38, 0x200000
    v_add_u32 v249, s38, v21
    s_mul_i32 s38, s36, 16
    s_lshr_b32 s39, s37, 3
    s_add_u32 s38, s38, s39
    s_lshl_b32 s38, s38, 7
    s_and_b32 s39, s37, 7
    s_add_u32 s38, s38, s39
    s_add_u32 s38, s38, 0x400000
    v_lshl_add_u32 v94, v1, 10, s38
    v_lshl_add_u32 v6, v23, 7, v5
    v_lshl_add_u32 v251, v2, 5, v6
    global_load_lds_dwordx4 v242, s[6:7] offset:2048 nt
    global_load_lds_dwordx4 v243, s[6:7] offset:3072 nt
    s_waitcnt vmcnt(7)
    s_xor_b32 m0, s53, 0x2000
    s_nop 0
    global_load_lds_dwordx4 v244, s[6:7] offset:0 nt
    s_waitcnt vmcnt(7)
    global_load_lds_dwordx4 v245, s[6:7] offset:1024 nt
    s_waitcnt vmcnt(7)
    global_load_lds_dwordx4 v244, s[6:7] offset:2048 nt
    s_waitcnt vmcnt(7)
    global_load_lds_dwordx4 v245, s[6:7] offset:3072 nt
    s_waitcnt vmcnt(7)
    s_xor_b32 m0, s53, 0x3000
    s_nop 0
    global_load_lds_dwordx4 v246, s[6:7] offset:0 nt
    s_waitcnt vmcnt(7)
    global_load_lds_dwordx4 v247, s[6:7] offset:1024 nt
    s_waitcnt vmcnt(7)
    global_load_lds_dwordx4 v246, s[6:7] offset:2048 nt
    s_waitcnt vmcnt(7)
    global_load_lds_dwordx4 v247, s[6:7] offset:3072 nt
    ds_write_b32 v250, v7 offset:15600
    s_waitcnt vmcnt(7)
    s_xor_b32 m0, s53, 0x10000
    s_nop 0
    global_load_lds_dwordx4 v240, s[8:9] offset:0 nt
    s_waitcnt vmcnt(7)
    global_load_lds_dwordx4 v241, s[8:9] offset:1024 nt
    s_waitcnt vmcnt(7)
    global_load_lds_dwordx4 v240, s[8:9] offset:2048 nt
    s_waitcnt vmcnt(7)
    global_load_lds_dwordx4 v241, s[8:9] offset:3072 nt
    s_waitcnt vmcnt(7)
    s_xor_b32 m0, s53, 0x11000
    s_nop 0
    global_load_lds_dwordx4 v242, s[8:9] offset:0 nt
    s_waitcnt vmcnt(7)
    global_load_lds_dwordx4 v243, s[8:9] offset:1024 nt
    s_waitcnt vmcnt(7)
    global_load_lds_dwordx4 v242, s[8:9] offset:2048 nt
    s_waitcnt vmcnt(7)
    global_load_lds_dwordx4 v243, s[8:9] offset:3072 nt
    ds_write_b32 v250, v7 offset:15472
    s_waitcnt vmcnt(7)
    s_xor_b32 m0, s53, 0x12000
    s_nop 0
    global_load_lds_dwordx4 v244, s[8:9] offset:0 nt
    s_waitcnt vmcnt(7)
    global_load_lds_dwordx4 v245, s[8:9] offset:1024 nt
    s_waitcnt vmcnt(7)
    global_load_lds_dwordx4 v244, s[8:9] offset:2048 nt
    s_waitcnt vmcnt(7)
    global_load_lds_dwordx4 v245, s[8:9] offset:3072 nt
    s_waitcnt vmcnt(7)
    s_xor_b32 m0, s53, 0x13000
    s_nop 0
    global_load_lds_dwordx4 v246, s[8:9] offset:0 nt
    s_waitcnt vmcnt(7)
    global_load_lds_dwordx4 v247, s[8:9] offset:1024 nt
    s_waitcnt vmcnt(7)
    global_load_lds_dwordx4 v246, s[8:9] offset:2048 nt
    s_waitcnt vmcnt(7)
    global_load_lds_dwordx4 v247, s[8:9] offset:3072 nt
    ds_write_b32 v250, v7 offset:15488
    s_waitcnt vmcnt(3)
    global_load_dwordx4 v[160:163], v248, s[12:13] nt
    v_add_u32 v248, 0x2000, v248
    s_waitcnt vmcnt(3)
    global_load_dwordx4 v[164:167], v248, s[12:13] nt
    v_add_u32 v248, 0x2000, v248
    s_waitcnt vmcnt(3)
    global_load_dwordx4 v[168:171], v248, s[12:13] nt
    v_add_u32 v248, 0x2000, v248
    s_waitcnt vmcnt(3)
    global_load_dwordx4 v[172:175], v248, s[12:13] nt
    v_add_u32 v248, 0x2000, v248
    ds_write_b32 v250, v7 offset:15504
    s_waitcnt vmcnt(3)
    global_load_dwordx4 v[176:179], v248, s[12:13] nt
    v_add_u32 v248, 0x2000, v248
    s_waitcnt vmcnt(3)
    global_load_dwordx4 v[180:183], v248, s[12:13] nt
    v_add_u32 v248, 0x2000, v248
    s_waitcnt vmcnt(3)
    global_load_dwordx4 v[184:187], v248, s[12:13] nt
    v_add_u32 v248, 0x2000, v248
    s_waitcnt vmcnt(3)
    global_load_dwordx4 v[188:191], v248, s[12:13] nt
    v_add_u32 v248, 0x2000, v248
    global_load_dwordx4 v[192:195], v248, s[12:13] nt
    v_add_u32 v248, 0x2000, v248
    global_load_dwordx4 v[196:199], v248, s[12:13] nt
    v_add_u32 v248, 0x2000, v248
    s_waitcnt vmcnt(5)
    global_load_dwordx4 v[200:203], v248, s[12:13] nt
    v_add_u32 v248, 0x2000, v248
    s_waitcnt vmcnt(5)
    global_load_dwordx4 v[204:207], v248, s[12:13] nt
    v_add_u32 v248, 0x2000, v248
    s_waitcnt vmcnt(5)
    global_load_dwordx4 v[208:211], v248, s[12:13] nt
    v_add_u32 v248, 0x2000, v248
    s_waitcnt vmcnt(5)
    global_load_dwordx4 v[212:215], v248, s[12:13] nt
    v_add_u32 v248, 0x2000, v248
    s_waitcnt vmcnt(5)
    global_load_dwordx4 v[216:219], v248, s[12:13] nt
    v_add_u32 v248, 0x2000, v248
    s_waitcnt vmcnt(5)
    global_load_dwordx4 v[220:223], v248, s[12:13] nt
L_BAj:
    s_mov_b32 s40, 200000
Llw_35:
    ds_read_b128 v[16:19], v5 offset:15440
    ds_read_b128 v[224:227], v251 offset:14976
    ds_read_b128 v[228:231], v251 offset:14992
    ds_read_b64 v[80:81], v252 offset:15360
    s_waitcnt lgkmcnt(3)
    v_bitop3_b32 v16, v16, v17, v18 bitop3:0x80
    v_and_b32 v16, v16, v19
    v_cmp_eq_u32 vcc, 0, v16
    s_cbranch_vccz Llwd_36
    s_sub_u32 s40, s40, 1
    s_cbranch_scc0 Llw_35
Llwd_36:
    s_waitcnt lgkmcnt(0)
    v_perm_b32 v32, v224, v224, v8
    v_perm_b32 v33, v224, v224, v9
    v_perm_b32 v34, v224, v224, v10
    v_perm_b32 v35, v224, v224, v11
    v_perm_b32 v36, v224, v224, v12
    v_perm_b32 v37, v224, v224, v13
    v_perm_b32 v38, v224, v224, v14
    v_perm_b32 v39, v224, v224, v15
    v_perm_b32 v40, v225, v225, v8
    v_perm_b32 v41, v225, v225, v9
    v_perm_b32 v42, v225, v225, v10
    v_perm_b32 v43, v225, v225, v11
    v_mfma_f32_16x16x32_bf16 v[64:67], v[32:35], v[160:163], 0
    v_perm_b32 v44, v225, v225, v12
    v_perm_b32 v45, v225, v225, v13
    v_perm_b32 v46, v225, v225, v14
    v_perm_b32 v47, v225, v225, v15
    v_mfma_f32_16x16x32_bf16 v[68:71], v[36:39], v[164:167], 0
    v_perm_b32 v32, v226, v226, v8
    v_perm_b32 v33, v226, v226, v9
    v_perm_b32 v34, v226, v226, v10
    v_perm_b32 v35, v226, v226, v11
    v_mfma_f32_16x16x32_bf16 v[64:67], v[40:43], v[168:171], v[64:67]
    v_perm_b32 v36, v226, v226, v12
    v_perm_b32 v37, v226, v226, v13
    v_perm_b32 v38, v226, v226, v14
    v_perm_b32 v39, v226, v226, v15
    v_mfma_f32_16x16x32_bf16 v[68:71], v[44:47], v[172:175], v[68:71]
    v_perm_b32 v40, v227, v227, v8
    v_perm_b32 v41, v227, v227, v9
    v_perm_b32 v42, v227, v227, v10
    v_perm_b32 v43, v227, v227, v11
    v_mfma_f32_16x16x32_bf16 v[64:67], v[32:35], v[176:179], v[64:67]
    v_perm_b32 v44, v227, v227, v12
    v_perm_b32 v45, v227, v227, v13
    v_perm_b32 v46, v227, v227, v14
    v_perm_b32 v47, v227, v227, v15
    v_mfma_f32_16x16x32_bf16 v[68:71], v[36:39], v[180:183], v[68:71]
    v_perm_b32 v32, v228, v228, v8
    v_perm_b32 v33, v228, v228, v9
    v_perm_b32 v34, v228, v228, v10
    v_perm_b32 v35, v228, v228, v11
    v_mfma_f32_16x16x32_bf16 v[64:67], v[40:43], v[184:187], v[64:67]
    v_perm_b32 v36, v228, v228, v12
    v_perm_b32 v37, v228, v228, v13
    v_perm_b32 v38, v228, v228, v14
    v_perm_b32 v39, v228, v228, v15
    v_mfma_f32_16x16x32_bf16 v[68:71], v[44:47], v[188:191], v[68:71]
    v_perm_b32 v40, v229, v229, v8
    v_perm_b32 v41, v229, v229, v9
    v_perm_b32 v42, v229, v229, v10
    v_perm_b32 v43, v229, v229, v11
    v_mfma_f32_16x16x32_bf16 v[64:67], v[32:35], v[192:195], v[64:67]
    v_perm_b32 v44, v229, v229, v12
    v_perm_b32 v45, v229, v229, v13
    v_perm_b32 v46, v229, v229, v14
    v_perm_b32 v47, v229, v229, v15
    v_mfma_f32_16x16x32_bf16 v[68:71], v[36:39], v[196:199], v[68:71]
    v_perm_b32 v32, v230, v230, v8
    v_perm_b32 v33, v230, v230, v9
    v_perm_b32 v34, v230, v230, v10
    v_perm_b32 v35, v230, v230, v11
    s_waitcnt vmcnt(5)
    v_mfma_f32_16x16x32_bf16 v[64:67], v[40:43], v[200:203], v[64:67]
    v_perm_b32 v36, v230, v230, v12
    v_perm_b32 v37, v230, v230, v13
    v_perm_b32 v38, v230, v230, v14
    v_perm_b32 v39, v230, v230, v15
    s_waitcnt vmcnt(4)
    v_mfma_f32_16x16x32_bf16 v[68:71], v[44:47], v[204:207], v[68:71]
    v_perm_b32 v40, v231, v231, v8
    v_perm_b32 v41, v231, v231, v9
    v_perm_b32 v42, v231, v231, v10
    v_perm_b32 v43, v231, v231, v11
    s_waitcnt vmcnt(3)
    v_mfma_f32_16x16x32_bf16 v[64:67], v[32:35], v[208:211], v[64:67]
    v_perm_b32 v44, v231, v231, v12
    v_perm_b32 v45, v231, v231, v13
    v_perm_b32 v46, v231, v231, v14
    v_perm_b32 v47, v231, v231, v15
    s_waitcnt vmcnt(2)
    v_mfma_f32_16x16x32_bf16 v[68:71], v[36:39], v[212:215], v[68:71]
    s_waitcnt vmcnt(1)
    v_mfma_f32_16x16x32_bf16 v[64:67], v[40:43], v[216:219], v[64:67]
    s_waitcnt vmcnt(0)
    s_mov_b64 exec, 0x3
    global_store_byte v94, v4, s[96:97] sc1
    s_mov_b64 exec, -1
    v_mfma_f32_16x16x32_bf16 v[68:71], v[44:47], v[220:223], v[68:71]
    s_nop 7
    v_pk_add_f32 v[64:65], v[64:65], v[68:69]
    v_pk_add_f32 v[66:67], v[66:67], v[70:71]
    v_pk_mul_f32 v[64:65], v[64:65], v[80:81] op_sel_hi:[1,0]
    v_pk_mul_f32 v[66:67], v[66:67], v[80:81] op_sel_hi:[1,0]
    v_bfi_b32 v64, s44, v4, v64
    v_bfi_b32 v65, s44, v4, v65
    v_bfi_b32 v66, s44, v4, v66
    v_bfi_b32 v67, s44, v4, v67
    global_store_dwordx4 v249, v[64:67], s[96:97] sc1
    s_branch L_fin
L_BF:
    s_sub_u32 s30, s30, 4
    s_lshl_b32 s38, s30, 2
    v_add_u32 v250, s38, v5
    v_lshlrev_b32 v22, 11, v2
    v_lshl_add_u32 v22, v3, 4, v22
    v_lshrrev_b32 v23, 3, v3
    v_and_b32 v6, 1, v2
    v_lshlrev_b32 v6, 4, v6
    v_lshl_add_u32 v6, v3, 5, v6
    v_lshrrev_b32 v16, 1, v2
    v_lshl_add_u32 v21, v16, 12, v6
    v_lshl_add_u32 v252, v16, 3, v5
    s_cmp_lg_u32 s29, 1
    s_cbranch_scc1 L_BG
    s_waitcnt vmcnt(8)
    v_perm_b32 v32, v24, v24, v8
    v_perm_b32 v33, v24, v24, v9
    v_perm_b32 v34, v24, v24, v10
    v_perm_b32 v35, v24, v24, v11
    v_perm_b32 v36, v24, v24, v12
    v_perm_b32 v37, v24, v24, v13
    v_perm_b32 v38, v24, v24, v14
    v_perm_b32 v39, v24, v24, v15
    v_perm_b32 v40, v25, v25, v8
    v_perm_b32 v41, v25, v25, v9
    v_perm_b32 v42, v25, v25, v10
    v_perm_b32 v43, v25, v25, v11
    v_perm_b32 v44, v25, v25, v12
    v_perm_b32 v45, v25, v25, v13
    v_perm_b32 v46, v25, v25, v14
    v_perm_b32 v47, v25, v25, v15
    v_perm_b32 v48, v26, v26, v8
    v_perm_b32 v49, v26, v26, v9
    v_perm_b32 v50, v26, v26, v10
    v_perm_b32 v51, v26, v26, v11
    v_perm_b32 v52, v26, v26, v12
    v_perm_b32 v53, v26, v26, v13
    v_perm_b32 v54, v26, v26, v14
    v_perm_b32 v55, v26, v26, v15
    v_perm_b32 v56, v27, v27, v8
    v_perm_b32 v57, v27, v27, v9
    v_perm_b32 v58, v27, v27, v10
    v_perm_b32 v59, v27, v27, v11
    v_perm_b32 v60, v27, v27, v12
    v_perm_b32 v61, v27, v27, v13
    v_perm_b32 v62, v27, v27, v14
    v_perm_b32 v63, v27, v27, v15
    v_perm_b32 v176, v28, v28, v8
    v_perm_b32 v177, v28, v28, v9
    v_perm_b32 v178, v28, v28, v10
    v_perm_b32 v179, v28, v28, v11
    v_perm_b32 v180, v28, v28, v12
    v_perm_b32 v181, v28, v28, v13
    v_perm_b32 v182, v28, v28, v14
    v_perm_b32 v183, v28, v28, v15
    v_perm_b32 v184, v29, v29, v8
    v_perm_b32 v185, v29, v29, v9
    v_perm_b32 v186, v29, v29, v10
    v_perm_b32 v187, v29, v29, v11
    v_perm_b32 v188, v29, v29, v12
    v_perm_b32 v189, v29, v29, v13
    v_perm_b32 v190, v29, v29, v14
    v_perm_b32 v191, v29, v29, v15
    v_perm_b32 v192, v30, v30, v8
    v_perm_b32 v193, v30, v30, v9
    v_perm_b32 v194, v30, v30, v10
    v_perm_b32 v195, v30, v30, v11
    v_perm_b32 v196, v30, v30, v12
    v_perm_b32 v197, v30, v30, v13
    v_perm_b32 v198, v30, v30, v14
    v_perm_b32 v199, v30, v30, v15
    v_perm_b32 v200, v31, v31, v8
    v_perm_b32 v201, v31, v31, v9
    v_perm_b32 v202, v31, v31, v10
    v_perm_b32 v203, v31, v31, v11
    v_perm_b32 v204, v31, v31, v12
    v_perm_b32 v205, v31, v31, v13
    v_perm_b32 v206, v31, v31, v14
    v_perm_b32 v207, v31, v31, v15
    s_waitcnt vmcnt(7)
    v_mfma_f32_16x16x32_bf16 v[80:83], v[32:35], v[64:67], 0
    v_mfma_f32_16x16x32_bf16 v[84:87], v[36:39], v[64:67], 0
    s_waitcnt vmcnt(6)
    v_mfma_f32_16x16x32_bf16 v[80:83], v[40:43], v[68:71], v[80:83]
    v_mfma_f32_16x16x32_bf16 v[84:87], v[44:47], v[68:71], v[84:87]
    s_waitcnt vmcnt(5)
    v_mfma_f32_16x16x32_bf16 v[80:83], v[48:51], v[72:75], v[80:83]
    v_mfma_f32_16x16x32_bf16 v[84:87], v[52:55], v[72:75], v[84:87]
    s_waitcnt vmcnt(4)
    v_mfma_f32_16x16x32_bf16 v[80:83], v[56:59], v[76:79], v[80:83]
    v_mfma_f32_16x16x32_bf16 v[84:87], v[60:63], v[76:79], v[84:87]
    s_waitcnt vmcnt(3)
    v_mfma_f32_16x16x32_bf16 v[80:83], v[176:179], v[160:163], v[80:83]
    v_mfma_f32_16x16x32_bf16 v[84:87], v[180:183], v[160:163], v[84:87]
    s_waitcnt vmcnt(2)
    v_mfma_f32_16x16x32_bf16 v[80:83], v[184:187], v[164:167], v[80:83]
    v_mfma_f32_16x16x32_bf16 v[84:87], v[188:191], v[164:167], v[84:87]
    s_waitcnt vmcnt(1)
    v_mfma_f32_16x16x32_bf16 v[80:83], v[192:195], v[168:171], v[80:83]
    v_mfma_f32_16x16x32_bf16 v[84:87], v[196:199], v[168:171], v[84:87]
    s_waitcnt vmcnt(0)
    v_mfma_f32_16x16x32_bf16 v[80:83], v[200:203], v[172:175], v[80:83]
    v_mfma_f32_16x16x32_bf16 v[84:87], v[204:207], v[172:175], v[84:87]
    v_mov_b32 v7, 1
    s_nop 6
    v_add_f32_dpp v80, v84, v80 row_ror:8 row_mask:0xf bank_mask:0xf
    v_add_f32_dpp v81, v85, v81 row_ror:8 row_mask:0xf bank_mask:0xf
    v_add_f32_dpp v82, v86, v82 row_ror:8 row_mask:0xf bank_mask:0xf
    v_add_f32_dpp v83, v87, v83 row_ror:8 row_mask:0xf bank_mask:0xf
    s_mov_b64 exec, s[46:47]
    ds_write_b128 v89, v[80:83] offset:8192
    s_mov_b64 exec, -1
    ds_write_b32 v92, v7 offset:15552
    s_branch L_fin
L_BG:
    s_lshl_b32 s39, s30, 8
    v_lshl_add_u32 v6, v2, 6, s39
    v_lshlrev_b32 v18, 11, v23
    v_lshl_add_u32 v241, v6, 1, v18
    v_add_u32 v6, v6, v23
    v_mul_u32_u24 v6, 7168, v6
    v_and_b32 v18, 7, v3
    v_lshl_add_u32 v6, v18, 4, v6
    s_lshr_b32 s38, s28, 1
    s_lshl_b32 s38, s38, 7
    v_add_u32 v240, s38, v6
    s_bitcmp1_b32 s28, 0
    s_cselect_b32 s16, s18, s16
    s_cselect_b32 s17, s19, s17
    global_load_dwordx4 v[208:211], v241, s[4:5] offset:0
    global_load_dwordx4 v[212:215], v241, s[4:5] offset:16
    global_load_dwordx4 v[216:219], v241, s[4:5] offset:32
    global_load_dwordx4 v[220:223], v241, s[4:5] offset:48
    global_load_dwordx4 v[224:227], v241, s[4:5] offset:64
    global_load_dwordx4 v[228:231], v241, s[4:5] offset:80
    global_load_dwordx4 v[232:235], v241, s[4:5] offset:96
    global_load_dwordx4 v[236:239], v241, s[4:5] offset:112
    s_cmp_lg_u32 s29, 2
    s_cbranch_scc1 L_nw2
    v_mov_b32 v7, 1
    s_bitcmp1_b32 s28, 1
    s_cbranch_scc1 L_S0
    global_load_dwordx4 v[160:163], v240, s[16:17] offset:128 nt
    global_load_dwordx4 v[96:99], v240, s[16:17] nt
    v_add_u32 v240, 14336, v240
    global_load_dwordx4 v[164:167], v240, s[16:17] offset:128 nt
    global_load_dwordx4 v[100:103], v240, s[16:17] nt
    v_add_u32 v240, 14336, v240
    global_load_dwordx4 v[168:171], v240, s[16:17] offset:128 nt
    global_load_dwordx4 v[104:107], v240, s[16:17] nt
    v_add_u32 v240, 14336, v240
    s_branch L_nw3
L_S0:
    v_add_u32 v240, 86016, v240
    global_load_dwordx4 v[120:123], v240, s[16:17] nt
    v_add_u32 v240, 14336, v240
    global_load_dwordx4 v[124:127], v240, s[16:17] nt
    v_add_u32 v240, 14336, v240
    global_load_dwordx4 v[128:131], v240, s[16:17] nt
    v_add_u32 v240, 14336, v240
    global_load_dwordx4 v[132:135], v240, s[16:17] nt
    v_add_u32 v240, 14336, v240
    global_load_dwordx4 v[136:139], v240, s[16:17] nt
    v_add_u32 v240, 14336, v240
    global_load_dwordx4 v[140:143], v240, s[16:17] nt
    v_add_u32 v240, 14336, v240
    global_load_dwordx4 v[144:147], v240, s[16:17] nt
    v_add_u32 v240, 14336, v240
    global_load_dwordx4 v[148:151], v240, s[16:17] nt
    v_add_u32 v240, 14336, v240
    s_branch L_nw3
L_NS:
    s_bitcmp1_b32 s28, 1
    s_cbranch_scc1 L_S1
    s_waitcnt vmcnt(5)
    global_load_dwordx4 v[172:175], v240, s[16:17] offset:128 nt
    v_perm_b32 v32, v208, v208, v8
    v_perm_b32 v33, v208, v208, v9
    v_perm_b32 v34, v208, v208, v10
    v_perm_b32 v35, v208, v208, v11
    v_perm_b32 v36, v208, v208, v12
    v_perm_b32 v37, v208, v208, v13
    v_perm_b32 v38, v208, v208, v14
    v_perm_b32 v39, v208, v208, v15
    v_mfma_f32_16x16x32_bf16 v[48:51], v[32:35], v[160:163], 0
    s_nop 0
    v_mfma_f32_16x16x32_bf16 v[52:55], v[36:39], v[160:163], 0
    s_waitcnt vmcnt(5)
    global_load_dwordx4 v[108:111], v240, s[16:17] nt
    v_add_u32 v240, 14336, v240
    v_mfma_f32_16x16x32_bf16 v[24:27], v[32:35], v[96:99], 0
    v_mfma_f32_16x16x32_bf16 v[28:31], v[36:39], v[96:99], 0
    v_perm_b32 v40, v209, v209, v8
    v_perm_b32 v41, v209, v209, v9
    v_perm_b32 v42, v209, v209, v10
    v_perm_b32 v43, v209, v209, v11
    v_perm_b32 v44, v209, v209, v12
    v_perm_b32 v45, v209, v209, v13
    v_perm_b32 v46, v209, v209, v14
    v_perm_b32 v47, v209, v209, v15
    s_waitcnt vmcnt(5)
    global_load_dwordx4 v[176:179], v240, s[16:17] offset:128 nt
    v_mfma_f32_16x16x32_bf16 v[48:51], v[40:43], v[164:167], v[48:51]
    v_mfma_f32_16x16x32_bf16 v[52:55], v[44:47], v[164:167], v[52:55]
    s_waitcnt vmcnt(5)
    global_load_dwordx4 v[112:115], v240, s[16:17] nt
    v_add_u32 v240, 14336, v240
    v_mfma_f32_16x16x32_bf16 v[24:27], v[40:43], v[100:103], v[24:27]
    v_mfma_f32_16x16x32_bf16 v[28:31], v[44:47], v[100:103], v[28:31]
    v_perm_b32 v32, v210, v210, v8
    v_perm_b32 v33, v210, v210, v9
    v_perm_b32 v34, v210, v210, v10
    v_perm_b32 v35, v210, v210, v11
    v_perm_b32 v36, v210, v210, v12
    v_perm_b32 v37, v210, v210, v13
    v_perm_b32 v38, v210, v210, v14
    v_perm_b32 v39, v210, v210, v15
    s_waitcnt vmcnt(5)
    global_load_dwordx4 v[180:183], v240, s[16:17] offset:128 nt
    v_mfma_f32_16x16x32_bf16 v[48:51], v[32:35], v[168:171], v[48:51]
    v_mfma_f32_16x16x32_bf16 v[52:55], v[36:39], v[168:171], v[52:55]
    s_waitcnt vmcnt(5)
    global_load_dwordx4 v[116:119], v240, s[16:17] nt
    v_add_u32 v240, 14336, v240
    v_mfma_f32_16x16x32_bf16 v[24:27], v[32:35], v[104:107], v[24:27]
    v_mfma_f32_16x16x32_bf16 v[28:31], v[36:39], v[104:107], v[28:31]
    v_perm_b32 v40, v211, v211, v8
    v_perm_b32 v41, v211, v211, v9
    v_perm_b32 v42, v211, v211, v10
    v_perm_b32 v43, v211, v211, v11
    v_perm_b32 v44, v211, v211, v12
    v_perm_b32 v45, v211, v211, v13
    v_perm_b32 v46, v211, v211, v14
    v_perm_b32 v47, v211, v211, v15
    s_waitcnt vmcnt(5)
    global_load_dwordx4 v[120:123], v240, s[16:17] nt
    v_add_u32 v240, 14336, v240
    v_mfma_f32_16x16x32_bf16 v[48:51], v[40:43], v[172:175], v[48:51]
    v_mfma_f32_16x16x32_bf16 v[52:55], v[44:47], v[172:175], v[52:55]
    s_waitcnt vmcnt(5)
    global_load_dwordx4 v[124:127], v240, s[16:17] nt
    v_add_u32 v240, 14336, v240
    v_mfma_f32_16x16x32_bf16 v[24:27], v[40:43], v[108:111], v[24:27]
    v_mfma_f32_16x16x32_bf16 v[28:31], v[44:47], v[108:111], v[28:31]
    v_perm_b32 v32, v212, v212, v8
    v_perm_b32 v33, v212, v212, v9
    v_perm_b32 v34, v212, v212, v10
    v_perm_b32 v35, v212, v212, v11
    v_perm_b32 v36, v212, v212, v12
    v_perm_b32 v37, v212, v212, v13
    v_perm_b32 v38, v212, v212, v14
    v_perm_b32 v39, v212, v212, v15
    s_waitcnt vmcnt(5)
    global_load_dwordx4 v[128:131], v240, s[16:17] nt
    v_add_u32 v240, 14336, v240
    v_mfma_f32_16x16x32_bf16 v[48:51], v[32:35], v[176:179], v[48:51]
    v_mfma_f32_16x16x32_bf16 v[52:55], v[36:39], v[176:179], v[52:55]
    s_waitcnt vmcnt(5)
    global_load_dwordx4 v[132:135], v240, s[16:17] nt
    v_add_u32 v240, 14336, v240
    v_mfma_f32_16x16x32_bf16 v[24:27], v[32:35], v[112:115], v[24:27]
    v_mfma_f32_16x16x32_bf16 v[28:31], v[36:39], v[112:115], v[28:31]
    v_perm_b32 v40, v213, v213, v8
    v_perm_b32 v41, v213, v213, v9
    v_perm_b32 v42, v213, v213, v10
    v_perm_b32 v43, v213, v213, v11
    v_perm_b32 v44, v213, v213, v12
    v_perm_b32 v45, v213, v213, v13
    v_perm_b32 v46, v213, v213, v14
    v_perm_b32 v47, v213, v213, v15
    s_waitcnt vmcnt(5)
    global_load_dwordx4 v[136:139], v240, s[16:17] nt
    v_add_u32 v240, 14336, v240
    v_mfma_f32_16x16x32_bf16 v[48:51], v[40:43], v[180:183], v[48:51]
    v_mfma_f32_16x16x32_bf16 v[52:55], v[44:47], v[180:183], v[52:55]
    s_nop 7
    v_add_f32_dpp v48, v52, v48 row_ror:8 row_mask:0xf bank_mask:0xf
    v_add_f32_dpp v49, v53, v49 row_ror:8 row_mask:0xf bank_mask:0xf
    v_add_f32_dpp v50, v54, v50 row_ror:8 row_mask:0xf bank_mask:0xf
    v_add_f32_dpp v51, v55, v51 row_ror:8 row_mask:0xf bank_mask:0xf
    ds_write_b128 v242, v[48:51] offset:8192
    ds_write_b32 v250, v7 offset:15472
    s_waitcnt vmcnt(5)
    global_load_dwordx4 v[140:143], v240, s[16:17] nt
    v_add_u32 v240, 14336, v240
    v_mfma_f32_16x16x32_bf16 v[24:27], v[40:43], v[116:119], v[24:27]
    v_mfma_f32_16x16x32_bf16 v[28:31], v[44:47], v[116:119], v[28:31]
    v_perm_b32 v32, v214, v214, v8
    v_perm_b32 v33, v214, v214, v9
    v_perm_b32 v34, v214, v214, v10
    v_perm_b32 v35, v214, v214, v11
    v_perm_b32 v36, v214, v214, v12
    v_perm_b32 v37, v214, v214, v13
    v_perm_b32 v38, v214, v214, v14
    v_perm_b32 v39, v214, v214, v15
    global_load_dwordx4 v[144:147], v240, s[16:17] nt
    v_add_u32 v240, 14336, v240
    global_load_dwordx4 v[148:151], v240, s[16:17] nt
    v_add_u32 v240, 14336, v240
    s_branch L_Gent
L_S1:
    v_mov_b32 v24, 0
    v_mov_b32 v25, 0
    v_mov_b32 v26, 0
    v_mov_b32 v27, 0
    v_mov_b32 v28, 0
    v_mov_b32 v29, 0
    v_mov_b32 v30, 0
    v_mov_b32 v31, 0
    s_waitcnt vmcnt(8)
    v_perm_b32 v32, v214, v214, v8
    v_perm_b32 v33, v214, v214, v9
    v_perm_b32 v34, v214, v214, v10
    v_perm_b32 v35, v214, v214, v11
    v_perm_b32 v36, v214, v214, v12
    v_perm_b32 v37, v214, v214, v13
    v_perm_b32 v38, v214, v214, v14
    v_perm_b32 v39, v214, v214, v15
    s_branch L_Gent
L_nw2:
    s_waitcnt vmcnt(16)
    v_perm_b32 v32, v24, v24, v8
    v_perm_b32 v33, v24, v24, v9
    v_perm_b32 v34, v24, v24, v10
    v_perm_b32 v35, v24, v24, v11
    v_perm_b32 v36, v24, v24, v12
    v_perm_b32 v37, v24, v24, v13
    v_perm_b32 v38, v24, v24, v14
    v_perm_b32 v39, v24, v24, v15
    v_perm_b32 v40, v25, v25, v8
    v_perm_b32 v41, v25, v25, v9
    v_perm_b32 v42, v25, v25, v10
    v_perm_b32 v43, v25, v25, v11
    v_perm_b32 v44, v25, v25, v12
    v_perm_b32 v45, v25, v25, v13
    v_perm_b32 v46, v25, v25, v14
    v_perm_b32 v47, v25, v25, v15
    v_perm_b32 v48, v26, v26, v8
    v_perm_b32 v49, v26, v26, v9
    v_perm_b32 v50, v26, v26, v10
    v_perm_b32 v51, v26, v26, v11
    v_perm_b32 v52, v26, v26, v12
    v_perm_b32 v53, v26, v26, v13
    v_perm_b32 v54, v26, v26, v14
    v_perm_b32 v55, v26, v26, v15
    v_perm_b32 v56, v27, v27, v8
    v_perm_b32 v57, v27, v27, v9
    v_perm_b32 v58, v27, v27, v10
    v_perm_b32 v59, v27, v27, v11
    v_perm_b32 v60, v27, v27, v12
    v_perm_b32 v61, v27, v27, v13
    v_perm_b32 v62, v27, v27, v14
    v_perm_b32 v63, v27, v27, v15
    v_perm_b32 v176, v28, v28, v8
    v_perm_b32 v177, v28, v28, v9
    v_perm_b32 v178, v28, v28, v10
    v_perm_b32 v179, v28, v28, v11
    v_perm_b32 v180, v28, v28, v12
    v_perm_b32 v181, v28, v28, v13
    v_perm_b32 v182, v28, v28, v14
    v_perm_b32 v183, v28, v28, v15
    v_perm_b32 v184, v29, v29, v8
    v_perm_b32 v185, v29, v29, v9
    v_perm_b32 v186, v29, v29, v10
    v_perm_b32 v187, v29, v29, v11
    v_perm_b32 v188, v29, v29, v12
    v_perm_b32 v189, v29, v29, v13
    v_perm_b32 v190, v29, v29, v14
    v_perm_b32 v191, v29, v29, v15
    v_perm_b32 v192, v30, v30, v8
    v_perm_b32 v193, v30, v30, v9
    v_perm_b32 v194, v30, v30, v10
    v_perm_b32 v195, v30, v30, v11
    v_perm_b32 v196, v30, v30, v12
    v_perm_b32 v197, v30, v30, v13
    v_perm_b32 v198, v30, v30, v14
    v_perm_b32 v199, v30, v30, v15
    v_perm_b32 v200, v31, v31, v8
    v_perm_b32 v201, v31, v31, v9
    v_perm_b32 v202, v31, v31, v10
    v_perm_b32 v203, v31, v31, v11
    v_perm_b32 v204, v31, v31, v12
    v_perm_b32 v205, v31, v31, v13
    v_perm_b32 v206, v31, v31, v14
    v_perm_b32 v207, v31, v31, v15
    s_waitcnt vmcnt(15)
    v_mfma_f32_16x16x32_bf16 v[80:83], v[32:35], v[64:67], 0
    v_mfma_f32_16x16x32_bf16 v[84:87], v[36:39], v[64:67], 0
    s_waitcnt vmcnt(14)
    v_mfma_f32_16x16x32_bf16 v[80:83], v[40:43], v[68:71], v[80:83]
    v_mfma_f32_16x16x32_bf16 v[84:87], v[44:47], v[68:71], v[84:87]
    s_waitcnt vmcnt(13)
    v_mfma_f32_16x16x32_bf16 v[80:83], v[48:51], v[72:75], v[80:83]
    v_mfma_f32_16x16x32_bf16 v[84:87], v[52:55], v[72:75], v[84:87]
    s_waitcnt vmcnt(12)
    v_mfma_f32_16x16x32_bf16 v[80:83], v[56:59], v[76:79], v[80:83]
    v_mfma_f32_16x16x32_bf16 v[84:87], v[60:63], v[76:79], v[84:87]
    s_waitcnt vmcnt(11)
    global_load_dwordx4 v[96:99], v240, s[16:17] nt
    v_add_u32 v240, 14336, v240
    v_mfma_f32_16x16x32_bf16 v[80:83], v[176:179], v[160:163], v[80:83]
    v_mfma_f32_16x16x32_bf16 v[84:87], v[180:183], v[160:163], v[84:87]
    s_waitcnt vmcnt(11)
    global_load_dwordx4 v[100:103], v240, s[16:17] nt
    v_add_u32 v240, 14336, v240
    v_mfma_f32_16x16x32_bf16 v[80:83], v[184:187], v[164:167], v[80:83]
    v_mfma_f32_16x16x32_bf16 v[84:87], v[188:191], v[164:167], v[84:87]
    s_waitcnt vmcnt(11)
    global_load_dwordx4 v[104:107], v240, s[16:17] nt
    v_add_u32 v240, 14336, v240
    v_mfma_f32_16x16x32_bf16 v[80:83], v[192:195], v[168:171], v[80:83]
    v_mfma_f32_16x16x32_bf16 v[84:87], v[196:199], v[168:171], v[84:87]
    s_waitcnt vmcnt(11)
    global_load_dwordx4 v[108:111], v240, s[16:17] nt
    v_add_u32 v240, 14336, v240
    v_mfma_f32_16x16x32_bf16 v[80:83], v[200:203], v[172:175], v[80:83]
    v_mfma_f32_16x16x32_bf16 v[84:87], v[204:207], v[172:175], v[84:87]
    v_mov_b32 v7, 1
    s_nop 6
    v_add_f32_dpp v80, v84, v80 row_ror:8 row_mask:0xf bank_mask:0xf
    v_add_f32_dpp v81, v85, v81 row_ror:8 row_mask:0xf bank_mask:0xf
    v_add_f32_dpp v82, v86, v82 row_ror:8 row_mask:0xf bank_mask:0xf
    v_add_f32_dpp v83, v87, v83 row_ror:8 row_mask:0xf bank_mask:0xf
    s_mov_b64 exec, s[46:47]
    ds_write_b128 v89, v[80:83] offset:8192
    s_mov_b64 exec, -1
    ds_write_b32 v92, v7 offset:15552
L_nw3:
    s_lshr_b32 s37, s28, 1
    s_and_b32 s36, s28, 1
    s_lshl2_add_u32 s36, s36, s30
    s_lshl_b32 s38, s37, 9
    s_add_u32 s38, s38, s36
    s_lshl_b32 s38, s38, 8
    v_add_u32 v248, s38, v22
    s_lshl4_add_u32 s38, s37, s36
    s_lshl_b32 s38, s38, 9
    s_add_u32 s38, s38, 0x280000
    v_add_u32 v249, s38, v21
    s_mul_i32 s38, s36, 32
    s_bfe_u32 s39, s28, 0x20004
    s_lshl2_add_u32 s38, s39, s38
    s_lshr_b32 s39, s28, 6
    s_add_u32 s38, s38, s39
    s_lshl_b32 s38, s38, 7
    s_and_b32 s39, s37, 7
    s_add_u32 s38, s38, s39
    s_add_u32 s38, s38, 0x420000
    v_lshl_add_u32 v94, v1, 11, s38
    v_lshl_add_u32 v6, v23, 7, v5
    v_lshl_add_u32 v251, v2, 5, v6
    s_lshl_b32 s38, s30, 10
    v_lshl_add_u32 v6, v1, 4, v5
    v_add_u32 v242, s38, v6
    s_xor_b32 vcc_lo, s29, 2
    s_mov_b32 vcc_hi, 0
    s_cmp_eq_u32 s29, 2
    s_cbranch_scc1 L_NS
    s_cbranch_scc1 Lth_37
    s_waitcnt vmcnt(5)
Lth_37:
    s_cbranch_vccnz Lth_38
    s_waitcnt vmcnt(3)
Lth_38:
    s_waitcnt vmcnt(7)
    global_load_dwordx4 v[112:115], v240, s[16:17] nt
    v_add_u32 v240, 14336, v240
    s_cbranch_scc1 Lth_39
    s_waitcnt vmcnt(5)
Lth_39:
    s_cbranch_vccnz Lth_40
    s_waitcnt vmcnt(3)
Lth_40:
    s_waitcnt vmcnt(7)
    global_load_dwordx4 v[116:119], v240, s[16:17] nt
    v_add_u32 v240, 14336, v240
    s_cbranch_scc1 Lth_41
    s_waitcnt vmcnt(5)
Lth_41:
    s_cbranch_vccnz Lth_42
    s_waitcnt vmcnt(3)
Lth_42:
    s_waitcnt vmcnt(7)
    global_load_dwordx4 v[120:123], v240, s[16:17] nt
    v_add_u32 v240, 14336, v240
    s_cbranch_scc1 Lth_43
    s_waitcnt vmcnt(5)
Lth_43:
    s_cbranch_vccnz Lth_44
    s_waitcnt vmcnt(3)
Lth_44:
    s_waitcnt vmcnt(7)
    global_load_dwordx4 v[124:127], v240, s[16:17] nt
    v_add_u32 v240, 14336, v240
    v_perm_b32 v32, v208, v208, v8
    v_perm_b32 v33, v208, v208, v9
    v_perm_b32 v34, v208, v208, v10
    v_perm_b32 v35, v208, v208, v11
    v_perm_b32 v36, v208, v208, v12
    v_perm_b32 v37, v208, v208, v13
    v_perm_b32 v38, v208, v208, v14
    v_perm_b32 v39, v208, v208, v15
    s_cbranch_scc1 Lth_45
    s_waitcnt vmcnt(5)
Lth_45:
    s_cbranch_vccnz Lth_46
    s_waitcnt vmcnt(3)
Lth_46:
    s_waitcnt vmcnt(7)
    global_load_dwordx4 v[128:131], v240, s[16:17] nt
    v_add_u32 v240, 14336, v240
    v_mfma_f32_16x16x32_bf16 v[24:27], v[32:35], v[96:99], 0
    v_mfma_f32_16x16x32_bf16 v[28:31], v[36:39], v[96:99], 0
    v_perm_b32 v40, v209, v209, v8
    v_perm_b32 v41, v209, v209, v9
    v_perm_b32 v42, v209, v209, v10
    v_perm_b32 v43, v209, v209, v11
    v_perm_b32 v44, v209, v209, v12
    v_perm_b32 v45, v209, v209, v13
    v_perm_b32 v46, v209, v209, v14
    v_perm_b32 v47, v209, v209, v15
    s_cbranch_scc1 Lth_47
    s_waitcnt vmcnt(5)
Lth_47:
    s_cbranch_vccnz Lth_48
    s_waitcnt vmcnt(3)
Lth_48:
    s_waitcnt vmcnt(7)
    global_load_dwordx4 v[132:135], v240, s[16:17] nt
    v_add_u32 v240, 14336, v240
    v_mfma_f32_16x16x32_bf16 v[24:27], v[40:43], v[100:103], v[24:27]
    v_mfma_f32_16x16x32_bf16 v[28:31], v[44:47], v[100:103], v[28:31]
    v_perm_b32 v32, v210, v210, v8
    v_perm_b32 v33, v210, v210, v9
    v_perm_b32 v34, v210, v210, v10
    v_perm_b32 v35, v210, v210, v11
    v_perm_b32 v36, v210, v210, v12
    v_perm_b32 v37, v210, v210, v13
    v_perm_b32 v38, v210, v210, v14
    v_perm_b32 v39, v210, v210, v15
    s_cbranch_scc1 Lth_49
    s_waitcnt vmcnt(5)
Lth_49:
    s_cbranch_vccnz Lth_50
    s_waitcnt vmcnt(3)
Lth_50:
    s_waitcnt vmcnt(7)
    global_load_dwordx4 v[136:139], v240, s[16:17] nt
    v_add_u32 v240, 14336, v240
    v_mfma_f32_16x16x32_bf16 v[24:27], v[32:35], v[104:107], v[24:27]
    v_mfma_f32_16x16x32_bf16 v[28:31], v[36:39], v[104:107], v[28:31]
    v_perm_b32 v40, v211, v211, v8
    v_perm_b32 v41, v211, v211, v9
    v_perm_b32 v42, v211, v211, v10
    v_perm_b32 v43, v211, v211, v11
    v_perm_b32 v44, v211, v211, v12
    v_perm_b32 v45, v211, v211, v13
    v_perm_b32 v46, v211, v211, v14
    v_perm_b32 v47, v211, v211, v15
    s_cbranch_scc1 Lth_51
    s_waitcnt vmcnt(5)
Lth_51:
    s_cbranch_vccnz Lth_52
    s_waitcnt vmcnt(3)
Lth_52:
    s_waitcnt vmcnt(7)
    global_load_dwordx4 v[140:143], v240, s[16:17] nt
    v_add_u32 v240, 14336, v240
    v_mfma_f32_16x16x32_bf16 v[24:27], v[40:43], v[108:111], v[24:27]
    v_mfma_f32_16x16x32_bf16 v[28:31], v[44:47], v[108:111], v[28:31]
    v_perm_b32 v32, v212, v212, v8
    v_perm_b32 v33, v212, v212, v9
    v_perm_b32 v34, v212, v212, v10
    v_perm_b32 v35, v212, v212, v11
    v_perm_b32 v36, v212, v212, v12
    v_perm_b32 v37, v212, v212, v13
    v_perm_b32 v38, v212, v212, v14
    v_perm_b32 v39, v212, v212, v15
    s_waitcnt vmcnt(7)
    global_load_dwordx4 v[144:147], v240, s[16:17] nt
    v_add_u32 v240, 14336, v240
    v_mfma_f32_16x16x32_bf16 v[24:27], v[32:35], v[112:115], v[24:27]
    v_mfma_f32_16x16x32_bf16 v[28:31], v[36:39], v[112:115], v[28:31]
    v_perm_b32 v40, v213, v213, v8
    v_perm_b32 v41, v213, v213, v9
    v_perm_b32 v42, v213, v213, v10
    v_perm_b32 v43, v213, v213, v11
    v_perm_b32 v44, v213, v213, v12
    v_perm_b32 v45, v213, v213, v13
    v_perm_b32 v46, v213, v213, v14
    v_perm_b32 v47, v213, v213, v15
    s_waitcnt vmcnt(7)
    global_load_dwordx4 v[148:151], v240, s[16:17] nt
    v_add_u32 v240, 14336, v240
    v_mfma_f32_16x16x32_bf16 v[24:27], v[40:43], v[116:119], v[24:27]
    v_mfma_f32_16x16x32_bf16 v[28:31], v[44:47], v[116:119], v[28:31]
    v_perm_b32 v32, v214, v214, v8
    v_perm_b32 v33, v214, v214, v9
    v_perm_b32 v34, v214, v214, v10
    v_perm_b32 v35, v214, v214, v11
    v_perm_b32 v36, v214, v214, v12
    v_perm_b32 v37, v214, v214, v13
    v_perm_b32 v38, v214, v214, v14
    v_perm_b32 v39, v214, v214, v15
L_Gent:
    s_waitcnt vmcnt(7)
    global_load_dwordx4 v[152:155], v240, s[16:17] nt
    v_add_u32 v240, 14336, v240
    v_mfma_f32_16x16x32_bf16 v[24:27], v[32:35], v[120:123], v[24:27]
    v_mfma_f32_16x16x32_bf16 v[28:31], v[36:39], v[120:123], v[28:31]
    v_perm_b32 v40, v215, v215, v8
    v_perm_b32 v41, v215, v215, v9
    v_perm_b32 v42, v215, v215, v10
    v_perm_b32 v43, v215, v215, v11
    v_perm_b32 v44, v215, v215, v12
    v_perm_b32 v45, v215, v215, v13
    v_perm_b32 v46, v215, v215, v14
    v_perm_b32 v47, v215, v215, v15
    s_waitcnt vmcnt(7)
    global_load_dwordx4 v[156:159], v240, s[16:17] nt
    v_add_u32 v240, 14336, v240
    v_mfma_f32_16x16x32_bf16 v[24:27], v[40:43], v[124:127], v[24:27]
    v_mfma_f32_16x16x32_bf16 v[28:31], v[44:47], v[124:127], v[28:31]
    v_perm_b32 v32, v216, v216, v8
    v_perm_b32 v33, v216, v216, v9
    v_perm_b32 v34, v216, v216, v10
    v_perm_b32 v35, v216, v216, v11
    v_perm_b32 v36, v216, v216, v12
    v_perm_b32 v37, v216, v216, v13
    v_perm_b32 v38, v216, v216, v14
    v_perm_b32 v39, v216, v216, v15
    s_waitcnt vmcnt(7)
    global_load_dwordx4 v[96:99], v240, s[16:17] nt
    v_add_u32 v240, 14336, v240
    v_mfma_f32_16x16x32_bf16 v[24:27], v[32:35], v[128:131], v[24:27]
    v_mfma_f32_16x16x32_bf16 v[28:31], v[36:39], v[128:131], v[28:31]
    v_perm_b32 v40, v217, v217, v8
    v_perm_b32 v41, v217, v217, v9
    v_perm_b32 v42, v217, v217, v10
    v_perm_b32 v43, v217, v217, v11
    v_perm_b32 v44, v217, v217, v12
    v_perm_b32 v45, v217, v217, v13
    v_perm_b32 v46, v217, v217, v14
    v_perm_b32 v47, v217, v217, v15
    s_waitcnt vmcnt(7)
    global_load_dwordx4 v[100:103], v240, s[16:17] nt
    v_add_u32 v240, 14336, v240
    v_mfma_f32_16x16x32_bf16 v[24:27], v[40:43], v[132:135], v[24:27]
    v_mfma_f32_16x16x32_bf16 v[28:31], v[44:47], v[132:135], v[28:31]
    v_perm_b32 v32, v218, v218, v8
    v_perm_b32 v33, v218, v218, v9
    v_perm_b32 v34, v218, v218, v10
    v_perm_b32 v35, v218, v218, v11
    v_perm_b32 v36, v218, v218, v12
    v_perm_b32 v37, v218, v218, v13
    v_perm_b32 v38, v218, v218, v14
    v_perm_b32 v39, v218, v218, v15
    s_waitcnt vmcnt(7)
    global_load_dwordx4 v[104:107], v240, s[16:17] nt
    v_add_u32 v240, 14336, v240
    v_mfma_f32_16x16x32_bf16 v[24:27], v[32:35], v[136:139], v[24:27]
    v_mfma_f32_16x16x32_bf16 v[28:31], v[36:39], v[136:139], v[28:31]
    v_perm_b32 v40, v219, v219, v8
    v_perm_b32 v41, v219, v219, v9
    v_perm_b32 v42, v219, v219, v10
    v_perm_b32 v43, v219, v219, v11
    v_perm_b32 v44, v219, v219, v12
    v_perm_b32 v45, v219, v219, v13
    v_perm_b32 v46, v219, v219, v14
    v_perm_b32 v47, v219, v219, v15
    s_waitcnt vmcnt(7)
    global_load_dwordx4 v[108:111], v240, s[16:17] nt
    v_add_u32 v240, 14336, v240
    v_mfma_f32_16x16x32_bf16 v[24:27], v[40:43], v[140:143], v[24:27]
    v_mfma_f32_16x16x32_bf16 v[28:31], v[44:47], v[140:143], v[28:31]
    v_perm_b32 v32, v220, v220, v8
    v_perm_b32 v33, v220, v220, v9
    v_perm_b32 v34, v220, v220, v10
    v_perm_b32 v35, v220, v220, v11
    v_perm_b32 v36, v220, v220, v12
    v_perm_b32 v37, v220, v220, v13
    v_perm_b32 v38, v220, v220, v14
    v_perm_b32 v39, v220, v220, v15
    s_waitcnt vmcnt(7)
    global_load_dwordx4 v[112:115], v240, s[16:17] nt
    v_add_u32 v240, 14336, v240
    v_mfma_f32_16x16x32_bf16 v[24:27], v[32:35], v[144:147], v[24:27]
    v_mfma_f32_16x16x32_bf16 v[28:31], v[36:39], v[144:147], v[28:31]
    v_perm_b32 v40, v221, v221, v8
    v_perm_b32 v41, v221, v221, v9
    v_perm_b32 v42, v221, v221, v10
    v_perm_b32 v43, v221, v221, v11
    v_perm_b32 v44, v221, v221, v12
    v_perm_b32 v45, v221, v221, v13
    v_perm_b32 v46, v221, v221, v14
    v_perm_b32 v47, v221, v221, v15
    s_waitcnt vmcnt(7)
    global_load_dwordx4 v[116:119], v240, s[16:17] nt
    v_add_u32 v240, 14336, v240
    v_mfma_f32_16x16x32_bf16 v[24:27], v[40:43], v[148:151], v[24:27]
    v_mfma_f32_16x16x32_bf16 v[28:31], v[44:47], v[148:151], v[28:31]
    v_perm_b32 v32, v222, v222, v8
    v_perm_b32 v33, v222, v222, v9
    v_perm_b32 v34, v222, v222, v10
    v_perm_b32 v35, v222, v222, v11
    v_perm_b32 v36, v222, v222, v12
    v_perm_b32 v37, v222, v222, v13
    v_perm_b32 v38, v222, v222, v14
    v_perm_b32 v39, v222, v222, v15
    s_waitcnt vmcnt(7)
    global_load_dwordx4 v[120:123], v240, s[16:17] nt
    v_add_u32 v240, 14336, v240
    v_mfma_f32_16x16x32_bf16 v[24:27], v[32:35], v[152:155], v[24:27]
    v_mfma_f32_16x16x32_bf16 v[28:31], v[36:39], v[152:155], v[28:31]
    v_perm_b32 v40, v223, v223, v8
    v_perm_b32 v41, v223, v223, v9
    v_perm_b32 v42, v223, v223, v10
    v_perm_b32 v43, v223, v223, v11
    v_perm_b32 v44, v223, v223, v12
    v_perm_b32 v45, v223, v223, v13
    v_perm_b32 v46, v223, v223, v14
    v_perm_b32 v47, v223, v223, v15
    s_waitcnt vmcnt(7)
    global_load_dwordx4 v[124:127], v240, s[16:17] nt
    v_add_u32 v240, 14336, v240
    v_mfma_f32_16x16x32_bf16 v[24:27], v[40:43], v[156:159], v[24:27]
    v_mfma_f32_16x16x32_bf16 v[28:31], v[44:47], v[156:159], v[28:31]
    v_perm_b32 v32, v224, v224, v8
    v_perm_b32 v33, v224, v224, v9
    v_perm_b32 v34, v224, v224, v10
    v_perm_b32 v35, v224, v224, v11
    v_perm_b32 v36, v224, v224, v12
    v_perm_b32 v37, v224, v224, v13
    v_perm_b32 v38, v224, v224, v14
    v_perm_b32 v39, v224, v224, v15
    s_waitcnt vmcnt(7)
    global_load_dwordx4 v[128:131], v240, s[16:17] nt
    v_add_u32 v240, 14336, v240
    v_mfma_f32_16x16x32_bf16 v[24:27], v[32:35], v[96:99], v[24:27]
    v_mfma_f32_16x16x32_bf16 v[28:31], v[36:39], v[96:99], v[28:31]
    v_perm_b32 v40, v225, v225, v8
    v_perm_b32 v41, v225, v225, v9
    v_perm_b32 v42, v225, v225, v10
    v_perm_b32 v43, v225, v225, v11
    v_perm_b32 v44, v225, v225, v12
    v_perm_b32 v45, v225, v225, v13
    v_perm_b32 v46, v225, v225, v14
    v_perm_b32 v47, v225, v225, v15
    s_waitcnt vmcnt(7)
    global_load_dwordx4 v[132:135], v240, s[16:17] nt
    v_add_u32 v240, 14336, v240
    v_mfma_f32_16x16x32_bf16 v[24:27], v[40:43], v[100:103], v[24:27]
    v_mfma_f32_16x16x32_bf16 v[28:31], v[44:47], v[100:103], v[28:31]
    v_perm_b32 v32, v226, v226, v8
    v_perm_b32 v33, v226, v226, v9
    v_perm_b32 v34, v226, v226, v10
    v_perm_b32 v35, v226, v226, v11
    v_perm_b32 v36, v226, v226, v12
    v_perm_b32 v37, v226, v226, v13
    v_perm_b32 v38, v226, v226, v14
    v_perm_b32 v39, v226, v226, v15
    s_waitcnt vmcnt(7)
    global_load_dwordx4 v[136:139], v240, s[16:17] nt
    v_add_u32 v240, 14336, v240
    v_mfma_f32_16x16x32_bf16 v[24:27], v[32:35], v[104:107], v[24:27]
    v_mfma_f32_16x16x32_bf16 v[28:31], v[36:39], v[104:107], v[28:31]
    v_perm_b32 v40, v227, v227, v8
    v_perm_b32 v41, v227, v227, v9
    v_perm_b32 v42, v227, v227, v10
    v_perm_b32 v43, v227, v227, v11
    v_perm_b32 v44, v227, v227, v12
    v_perm_b32 v45, v227, v227, v13
    v_perm_b32 v46, v227, v227, v14
    v_perm_b32 v47, v227, v227, v15
    s_waitcnt vmcnt(7)
    global_load_dwordx4 v[140:143], v240, s[16:17] nt
    v_add_u32 v240, 14336, v240
    v_mfma_f32_16x16x32_bf16 v[24:27], v[40:43], v[108:111], v[24:27]
    v_mfma_f32_16x16x32_bf16 v[28:31], v[44:47], v[108:111], v[28:31]
    v_perm_b32 v32, v228, v228, v8
    v_perm_b32 v33, v228, v228, v9
    v_perm_b32 v34, v228, v228, v10
    v_perm_b32 v35, v228, v228, v11
    v_perm_b32 v36, v228, v228, v12
    v_perm_b32 v37, v228, v228, v13
    v_perm_b32 v38, v228, v228, v14
    v_perm_b32 v39, v228, v228, v15
    s_waitcnt vmcnt(7)
    global_load_dwordx4 v[144:147], v240, s[16:17] nt
    v_add_u32 v240, 14336, v240
    v_mfma_f32_16x16x32_bf16 v[24:27], v[32:35], v[112:115], v[24:27]
    v_mfma_f32_16x16x32_bf16 v[28:31], v[36:39], v[112:115], v[28:31]
    v_perm_b32 v40, v229, v229, v8
    v_perm_b32 v41, v229, v229, v9
    v_perm_b32 v42, v229, v229, v10
    v_perm_b32 v43, v229, v229, v11
    v_perm_b32 v44, v229, v229, v12
    v_perm_b32 v45, v229, v229, v13
    v_perm_b32 v46, v229, v229, v14
    v_perm_b32 v47, v229, v229, v15
    s_waitcnt vmcnt(7)
    global_load_dwordx4 v[148:151], v240, s[16:17] nt
    v_add_u32 v240, 14336, v240
    v_mfma_f32_16x16x32_bf16 v[24:27], v[40:43], v[116:119], v[24:27]
    v_mfma_f32_16x16x32_bf16 v[28:31], v[44:47], v[116:119], v[28:31]
    v_perm_b32 v32, v230, v230, v8
    v_perm_b32 v33, v230, v230, v9
    v_perm_b32 v34, v230, v230, v10
    v_perm_b32 v35, v230, v230, v11
    v_perm_b32 v36, v230, v230, v12
    v_perm_b32 v37, v230, v230, v13
    v_perm_b32 v38, v230, v230, v14
    v_perm_b32 v39, v230, v230, v15
    s_waitcnt vmcnt(7)
    global_load_dwordx4 v[152:155], v240, s[16:17] nt
    v_add_u32 v240, 14336, v240
    v_mfma_f32_16x16x32_bf16 v[24:27], v[32:35], v[120:123], v[24:27]
    v_mfma_f32_16x16x32_bf16 v[28:31], v[36:39], v[120:123], v[28:31]
    v_perm_b32 v40, v231, v231, v8
    v_perm_b32 v41, v231, v231, v9
    v_perm_b32 v42, v231, v231, v10
    v_perm_b32 v43, v231, v231, v11
    v_perm_b32 v44, v231, v231, v12
    v_perm_b32 v45, v231, v231, v13
    v_perm_b32 v46, v231, v231, v14
    v_perm_b32 v47, v231, v231, v15
    s_waitcnt vmcnt(7)
    global_load_dwordx4 v[156:159], v240, s[16:17] nt
    v_mfma_f32_16x16x32_bf16 v[24:27], v[40:43], v[124:127], v[24:27]
    v_mfma_f32_16x16x32_bf16 v[28:31], v[44:47], v[124:127], v[28:31]
    v_perm_b32 v32, v232, v232, v8
    v_perm_b32 v33, v232, v232, v9
    v_perm_b32 v34, v232, v232, v10
    v_perm_b32 v35, v232, v232, v11
    v_perm_b32 v36, v232, v232, v12
    v_perm_b32 v37, v232, v232, v13
    v_perm_b32 v38, v232, v232, v14
    v_perm_b32 v39, v232, v232, v15
    s_waitcnt vmcnt(6)
    global_load_dwordx4 v[160:163], v248, s[20:21] nt
    v_add_u32 v248, 0x2000, v248
    v_mfma_f32_16x16x32_bf16 v[24:27], v[32:35], v[128:131], v[24:27]
    v_mfma_f32_16x16x32_bf16 v[28:31], v[36:39], v[128:131], v[28:31]
    v_perm_b32 v40, v233, v233, v8
    v_perm_b32 v41, v233, v233, v9
    v_perm_b32 v42, v233, v233, v10
    v_perm_b32 v43, v233, v233, v11
    v_perm_b32 v44, v233, v233, v12
    v_perm_b32 v45, v233, v233, v13
    v_perm_b32 v46, v233, v233, v14
    v_perm_b32 v47, v233, v233, v15
    v_mfma_f32_16x16x32_bf16 v[24:27], v[40:43], v[132:135], v[24:27]
    s_nop 0
    v_mfma_f32_16x16x32_bf16 v[28:31], v[44:47], v[132:135], v[28:31]
    v_perm_b32 v32, v234, v234, v8
    v_perm_b32 v33, v234, v234, v9
    v_perm_b32 v34, v234, v234, v10
    v_perm_b32 v35, v234, v234, v11
    v_perm_b32 v36, v234, v234, v12
    v_perm_b32 v37, v234, v234, v13
    v_perm_b32 v38, v234, v234, v14
    v_perm_b32 v39, v234, v234, v15
    s_waitcnt vmcnt(6)
    global_load_dwordx4 v[164:167], v248, s[20:21] nt
    v_add_u32 v248, 0x2000, v248
    v_mfma_f32_16x16x32_bf16 v[24:27], v[32:35], v[136:139], v[24:27]
    v_mfma_f32_16x16x32_bf16 v[28:31], v[36:39], v[136:139], v[28:31]
    v_perm_b32 v40, v235, v235, v8
    v_perm_b32 v41, v235, v235, v9
    v_perm_b32 v42, v235, v235, v10
    v_perm_b32 v43, v235, v235, v11
    v_perm_b32 v44, v235, v235, v12
    v_perm_b32 v45, v235, v235, v13
    v_perm_b32 v46, v235, v235, v14
    v_perm_b32 v47, v235, v235, v15
    s_waitcnt vmcnt(6)
    global_load_dwordx4 v[168:171], v248, s[20:21] nt
    v_add_u32 v248, 0x2000, v248
    v_mfma_f32_16x16x32_bf16 v[24:27], v[40:43], v[140:143], v[24:27]
    v_mfma_f32_16x16x32_bf16 v[28:31], v[44:47], v[140:143], v[28:31]
    v_perm_b32 v32, v236, v236, v8
    v_perm_b32 v33, v236, v236, v9
    v_perm_b32 v34, v236, v236, v10
    v_perm_b32 v35, v236, v236, v11
    v_perm_b32 v36, v236, v236, v12
    v_perm_b32 v37, v236, v236, v13
    v_perm_b32 v38, v236, v236, v14
    v_perm_b32 v39, v236, v236, v15
    s_waitcnt vmcnt(6)
    global_load_dwordx4 v[172:175], v248, s[20:21] nt
    v_add_u32 v248, 0x2000, v248
    v_mfma_f32_16x16x32_bf16 v[24:27], v[32:35], v[144:147], v[24:27]
    v_mfma_f32_16x16x32_bf16 v[28:31], v[36:39], v[144:147], v[28:31]
    v_perm_b32 v40, v237, v237, v8
    v_perm_b32 v41, v237, v237, v9
    v_perm_b32 v42, v237, v237, v10
    v_perm_b32 v43, v237, v237, v11
    v_perm_b32 v44, v237, v237, v12
    v_perm_b32 v45, v237, v237, v13
    v_perm_b32 v46, v237, v237, v14
    v_perm_b32 v47, v237, v237, v15
    s_waitcnt vmcnt(6)
    global_load_dwordx4 v[176:179], v248, s[20:21] nt
    v_add_u32 v248, 0x2000, v248
    v_mfma_f32_16x16x32_bf16 v[24:27], v[40:43], v[148:151], v[24:27]
    v_mfma_f32_16x16x32_bf16 v[28:31], v[44:47], v[148:151], v[28:31]
    v_perm_b32 v32, v238, v238, v8
    v_perm_b32 v33, v238, v238, v9
    v_perm_b32 v34, v238, v238, v10
    v_perm_b32 v35, v238, v238, v11
    v_perm_b32 v36, v238, v238, v12
    v_perm_b32 v37, v238, v238, v13
    v_perm_b32 v38, v238, v238, v14
    v_perm_b32 v39, v238, v238, v15
    s_waitcnt vmcnt(6)
    global_load_dwordx4 v[180:183], v248, s[20:21] nt
    v_add_u32 v248, 0x2000, v248
    v_mfma_f32_16x16x32_bf16 v[24:27], v[32:35], v[152:155], v[24:27]
    v_mfma_f32_16x16x32_bf16 v[28:31], v[36:39], v[152:155], v[28:31]
    v_perm_b32 v40, v239, v239, v8
    v_perm_b32 v41, v239, v239, v9
    v_perm_b32 v42, v239, v239, v10
    v_perm_b32 v43, v239, v239, v11
    v_perm_b32 v44, v239, v239, v12
    v_perm_b32 v45, v239, v239, v13
    v_perm_b32 v46, v239, v239, v14
    v_perm_b32 v47, v239, v239, v15
    s_waitcnt vmcnt(6)
    global_load_dwordx4 v[184:187], v248, s[20:21] nt
    v_add_u32 v248, 0x2000, v248
    v_mfma_f32_16x16x32_bf16 v[24:27], v[40:43], v[156:159], v[24:27]
    v_mfma_f32_16x16x32_bf16 v[28:31], v[44:47], v[156:159], v[28:31]
    s_nop 7
    v_add_f32_dpp v24, v28, v24 row_ror:8 row_mask:0xf bank_mask:0xf
    v_add_f32_dpp v25, v29, v25 row_ror:8 row_mask:0xf bank_mask:0xf
    v_add_f32_dpp v26, v30, v26 row_ror:8 row_mask:0xf bank_mask:0xf
    v_add_f32_dpp v27, v31, v27 row_ror:8 row_mask:0xf bank_mask:0xf
    ds_write_b128 v242, v[24:27] offset:4096
    ds_write_b32 v250, v7 offset:15520
    s_waitcnt vmcnt(6)
    global_load_dwordx4 v[188:191], v248, s[20:21] nt
    v_add_u32 v248, 0x2000, v248
    s_waitcnt vmcnt(6)
    global_load_dwordx4 v[192:195], v248, s[20:21] nt
    v_add_u32 v248, 0x2000, v248
    s_waitcnt vmcnt(6)
    global_load_dwordx4 v[196:199], v248, s[20:21] nt
    v_add_u32 v248, 0x2000, v248
    s_waitcnt vmcnt(6)
    global_load_dwordx4 v[200:203], v248, s[20:21] nt
    v_add_u32 v248, 0x2000, v248
    s_waitcnt vmcnt(6)
    global_load_dwordx4 v[204:207], v248, s[20:21] nt
    v_add_u32 v248, 0x2000, v248
    s_waitcnt vmcnt(6)
    global_load_dwordx4 v[208:211], v248, s[20:21] nt
    v_add_u32 v248, 0x2000, v248
    s_waitcnt vmcnt(6)
    global_load_dwordx4 v[212:215], v248, s[20:21] nt
    v_add_u32 v248, 0x2000, v248
    s_waitcnt vmcnt(6)
    global_load_dwordx4 v[216:219], v248, s[20:21] nt
    v_add_u32 v248, 0x2000, v248
    s_waitcnt vmcnt(6)
    global_load_dwordx4 v[220:223], v248, s[20:21] nt
    s_mov_b32 s40, 200000
Llw_53:
    ds_read_b128 v[16:19], v5 offset:15584
    ds_read_b128 v[224:227], v251 offset:14976
    ds_read_b128 v[228:231], v251 offset:14992
    ds_read_b64 v[80:81], v252 offset:15360
    s_waitcnt lgkmcnt(3)
    v_bitop3_b32 v16, v16, v17, v18 bitop3:0x80
    v_and_b32 v16, v16, v19
    v_cmp_eq_u32 vcc, 0, v16
    s_cbranch_vccz Llwd_54
    s_sub_u32 s40, s40, 1
    s_cbranch_scc0 Llw_53
Llwd_54:
    s_waitcnt lgkmcnt(0)
    v_perm_b32 v32, v224, v224, v8
    v_perm_b32 v33, v224, v224, v9
    v_perm_b32 v34, v224, v224, v10
    v_perm_b32 v35, v224, v224, v11
    v_perm_b32 v36, v224, v224, v12
    v_perm_b32 v37, v224, v224, v13
    v_perm_b32 v38, v224, v224, v14
    v_perm_b32 v39, v224, v224, v15
    v_perm_b32 v40, v225, v225, v8
    v_perm_b32 v41, v225, v225, v9
    v_perm_b32 v42, v225, v225, v10
    v_perm_b32 v43, v225, v225, v11
    v_mfma_f32_16x16x32_bf16 v[64:67], v[32:35], v[160:163], 0
    v_perm_b32 v44, v225, v225, v12
    v_perm_b32 v45, v225, v225, v13
    v_perm_b32 v46, v225, v225, v14
    v_perm_b32 v47, v225, v225, v15
    v_mfma_f32_16x16x32_bf16 v[68:71], v[36:39], v[164:167], 0
    v_perm_b32 v32, v226, v226, v8
    v_perm_b32 v33, v226, v226, v9
    v_perm_b32 v34, v226, v226, v10
    v_perm_b32 v35, v226, v226, v11
    v_mfma_f32_16x16x32_bf16 v[64:67], v[40:43], v[168:171], v[64:67]
    v_perm_b32 v36, v226, v226, v12
    v_perm_b32 v37, v226, v226, v13
    v_perm_b32 v38, v226, v226, v14
    v_perm_b32 v39, v226, v226, v15
    v_mfma_f32_16x16x32_bf16 v[68:71], v[44:47], v[172:175], v[68:71]
    v_perm_b32 v40, v227, v227, v8
    v_perm_b32 v41, v227, v227, v9
    v_perm_b32 v42, v227, v227, v10
    v_perm_b32 v43, v227, v227, v11
    v_mfma_f32_16x16x32_bf16 v[64:67], v[32:35], v[176:179], v[64:67]
    v_perm_b32 v44, v227, v227, v12
    v_perm_b32 v45, v227, v227, v13
    v_perm_b32 v46, v227, v227, v14
    v_perm_b32 v47, v227, v227, v15
    v_mfma_f32_16x16x32_bf16 v[68:71], v[36:39], v[180:183], v[68:71]
    v_perm_b32 v32, v228, v228, v8
    v_perm_b32 v33, v228, v228, v9
    v_perm_b32 v34, v228, v228, v10
    v_perm_b32 v35, v228, v228, v11
    v_mfma_f32_16x16x32_bf16 v[64:67], v[40:43], v[184:187], v[64:67]
    v_perm_b32 v36, v228, v228, v12
    v_perm_b32 v37, v228, v228, v13
    v_perm_b32 v38, v228, v228, v14
    v_perm_b32 v39, v228, v228, v15
    v_mfma_f32_16x16x32_bf16 v[68:71], v[44:47], v[188:191], v[68:71]
    v_perm_b32 v40, v229, v229, v8
    v_perm_b32 v41, v229, v229, v9
    v_perm_b32 v42, v229, v229, v10
    v_perm_b32 v43, v229, v229, v11
    v_mfma_f32_16x16x32_bf16 v[64:67], v[32:35], v[192:195], v[64:67]
    v_perm_b32 v44, v229, v229, v12
    v_perm_b32 v45, v229, v229, v13
    v_perm_b32 v46, v229, v229, v14
    v_perm_b32 v47, v229, v229, v15
    s_waitcnt vmcnt(6)
    v_mfma_f32_16x16x32_bf16 v[68:71], v[36:39], v[196:199], v[68:71]
    v_perm_b32 v32, v230, v230, v8
    v_perm_b32 v33, v230, v230, v9
    v_perm_b32 v34, v230, v230, v10
    v_perm_b32 v35, v230, v230, v11
    s_waitcnt vmcnt(5)
    v_mfma_f32_16x16x32_bf16 v[64:67], v[40:43], v[200:203], v[64:67]
    v_perm_b32 v36, v230, v230, v12
    v_perm_b32 v37, v230, v230, v13
    v_perm_b32 v38, v230, v230, v14
    v_perm_b32 v39, v230, v230, v15
    s_waitcnt vmcnt(4)
    v_mfma_f32_16x16x32_bf16 v[68:71], v[44:47], v[204:207], v[68:71]
    v_perm_b32 v40, v231, v231, v8
    v_perm_b32 v41, v231, v231, v9
    v_perm_b32 v42, v231, v231, v10
    v_perm_b32 v43, v231, v231, v11
    s_waitcnt vmcnt(3)
    v_mfma_f32_16x16x32_bf16 v[64:67], v[32:35], v[208:211], v[64:67]
    v_perm_b32 v44, v231, v231, v12
    v_perm_b32 v45, v231, v231, v13
    v_perm_b32 v46, v231, v231, v14
    v_perm_b32 v47, v231, v231, v15
    s_waitcnt vmcnt(2)
    v_mfma_f32_16x16x32_bf16 v[68:71], v[36:39], v[212:215], v[68:71]
    s_waitcnt vmcnt(1)
    v_mfma_f32_16x16x32_bf16 v[64:67], v[40:43], v[216:219], v[64:67]
    s_waitcnt vmcnt(0)
    s_mov_b64 exec, 0x3
    global_store_byte v94, v4, s[96:97] sc1
    s_mov_b64 exec, -1
    v_mfma_f32_16x16x32_bf16 v[68:71], v[44:47], v[220:223], v[68:71]
    s_nop 7
    v_pk_add_f32 v[64:65], v[64:65], v[68:69]
    v_pk_add_f32 v[66:67], v[66:67], v[70:71]
    v_pk_mul_f32 v[64:65], v[64:65], v[80:81] op_sel:[0,1]
    v_pk_mul_f32 v[66:67], v[66:67], v[80:81] op_sel:[0,1]
    v_bfi_b32 v64, s44, v4, v64
    v_bfi_b32 v65, s44, v4, v65
    v_bfi_b32 v66, s44, v4, v66
    v_bfi_b32 v67, s44, v4, v67
    global_store_dwordx4 v249, v[64:67], s[96:97] sc1
L_fin:
L_fin2:
    s_waitcnt vmcnt(0)
L_end:
    s_endpgm
L_codeend:
.section .rodata,"a"
.p2align 6
.amdhsa_kernel gated_mix__sliding_block_cached__geglu_ffn__decode_kernel
  .amdhsa_next_free_vgpr 256
  .amdhsa_next_free_sgpr 102
  .amdhsa_accum_offset 256
  .amdhsa_group_segment_fixed_size 0
  .amdhsa_kernarg_size 104
  .amdhsa_user_sgpr_count 2
  .amdhsa_user_sgpr_kernarg_segment_ptr 1
  .amdhsa_system_sgpr_workgroup_id_x 1
.end_amdhsa_kernel
```
